```python
import torch

def _softmax(x, axis=-1):
    return torch.softmax(x, dim=axis)
def _gelu(x):
    return torch.nn.functional.gelu(x, approximate="tanh")
def _silu(x):
    return torch.nn.functional.silu(x)
def _sigmoid(x):
    return torch.sigmoid(x)
def _layernorm(x, axis=-1, eps=1e-5):
    m = x.mean(dim=axis, keepdim=True)
    v = x.var(dim=axis, keepdim=True, unbiased=False)
    return (x - m) / torch.sqrt(v + eps)
def _scatter_add(tgt, idx, src, axis=0):
    return tgt.clone().index_add_(axis, idx, src)
def _segment_sum(src, seg, n):
    out = torch.zeros((n,) + src.shape[1:], dtype=src.dtype)
    return out.index_add_(0, seg, src)
def _pad(x, pw):
    flat = tuple(v for pair in reversed(pw) for v in pair)
    return torch.nn.functional.pad(x, flat)

kernel_name = 'parallel_sum__mha_block_cached__mixer_channel_mlp__decode'

def setup_inputs():

    _w = (lambda a: (lambda t: t.to(torch.bfloat16) if t.is_floating_point() else t)(torch.as_tensor(a)))
    def _A_setup():
        B, Sq, D = 8, 1, 576
        H, Sk, Dh = 32, 4096, 128
        return {
            "x": _w((lambda *s: torch.randn(*s, dtype=torch.bfloat16) * 0.05)(B, Sq, D)),
            "k_cache": _w((lambda *s: torch.randn(*s, dtype=torch.bfloat16) * 3.2)(B, H, Sk, Dh)),
            "v_cache": _w((lambda *s: torch.randn(*s, dtype=torch.bfloat16) * 0.4)(B, H, Sk, Dh)),
            "wq": _w((lambda *s: torch.randn(*s, dtype=torch.bfloat16) * 3.2)(D, H * Dh) * (D ** -0.5)),
            "wo": _w((lambda *s: torch.randn(*s, dtype=torch.bfloat16) * 0.4)(H * Dh, D) * ((H * Dh) ** -0.5)),
        }
    _A_in = _A_setup()

    def _B_setup():
        B, S, D, F = 8, 1, 576, 4608
        return {
            "x": _w((lambda *s: torch.randn(*s, dtype=torch.bfloat16) * 0.05)(B, S, D)),
            "w1": _w((lambda *s: torch.randn(*s, dtype=torch.bfloat16) * 3.2)(D, F) * (D ** -0.5)),
            "b1": _w((lambda *s: torch.randn(*s, dtype=torch.bfloat16) * 1.6)(F)),
            "w2": _w((lambda *s: torch.randn(*s, dtype=torch.bfloat16) * 0.1)(F, D) * (F ** -0.5)),
            "b2": _w((lambda *s: torch.randn(*s, dtype=torch.bfloat16) * 0.1)(D)),
        }
    _B_in = _B_setup()

    return {
        "A_x": _A_in["x"],
        "A_k_cache": _A_in["k_cache"],
        "A_v_cache": _A_in["v_cache"],
        "A_wq": _A_in["wq"],
        "A_wo": _A_in["wo"],
        "B_x": _B_in["x"],
        "B_w1": _B_in["w1"],
        "B_b1": _B_in["b1"],
        "B_w2": _B_in["w2"],
        "B_b2": _B_in["b2"],
    }

def reference(A_x, A_k_cache, A_v_cache, A_wq, A_wo, B_x, B_w1, B_b1, B_w2, B_b2):
    def _A_ref(x, k_cache, v_cache, wq, wo):
        B, Sq, D = x.shape
        H, Dh = 32, 128
        q = (lambda x, *d: x.permute(*d))((x @ wq).reshape(B, Sq, H, Dh), 0, 2, 1, 3)
        scores = torch.einsum("bhqd,bhkd->bhqk", q, k_cache) * (Dh ** -0.5)
        p = _softmax(scores, axis=-1)
        o = torch.einsum("bhqk,bhkd->bhqd", p, v_cache)
        return (lambda x, *d: x.permute(*d))(o, 0, 2, 1, 3).reshape(B, Sq, H * Dh) @ wo

    def _B_ref(x, w1, b1, w2, b2):
        y = _layernorm(x, axis=-1)
        h = _gelu(torch.einsum("bsd,df->bsf", y, w1) + b1)
        return torch.einsum("bsf,fd->bsd", h, w2) + b2

    x = A_x
    xn = _layernorm(x, axis=-1)
    return x + _A_ref(xn, A_k_cache, A_v_cache, A_wq, A_wo) + _B_ref(xn, B_w1, B_b1, B_w2, B_b2)
```

```asm
; @launch grid=(256,1,1) block=(512,1,1) lds=151808
.amdgcn_target "amdgcn-amd-amdhsa--gfx950"
.text
.globl parallel_sum__mha_block_cached__mixer_channel_mlp__decode_kernel
.p2align 8
.type parallel_sum__mha_block_cached__mixer_channel_mlp__decode_kernel,@function
parallel_sum__mha_block_cached__mixer_channel_mlp__decode_kernel:
  s_cmp_ge_u32 s2, 256
  s_cbranch_scc1 L_exit
  s_load_dwordx4 s[4:7], s[0:1], 8
  s_load_dwordx2 s[16:17], s[0:1], 0
  s_load_dwordx4 s[20:23], s[0:1], 24
  s_load_dwordx4 s[24:27], s[0:1], 48
  s_load_dwordx4 s[28:31], s[0:1], 64
  s_load_dwordx4 s[32:35], s[0:1], 80
  s_load_dwordx2 s[36:37], s[0:1], 96
  v_lshrrev_b32 v1, 6, v0
  s_lshr_b32 s38, s2, 5
  v_readfirstlane_b32 s3, v1
  s_and_b32 s39, s2, 31
  v_and_b32 v0, 63, v0
  s_nop 1
  s_cmp_ge_u32 s3, 4
  s_cbranch_scc1 L_side
L_stream:
  s_setprio 2
  s_lshl_b32 s44, s3, 13
  s_lshl_b32 s46, s3, 15
  v_lshrrev_b32 v13, 4, v0
  v_and_b32 v14, 15, v0
  v_add_u32 v2, 0, v13
  v_xor_b32 v2, v2, v14
  v_lshlrev_b32 v2, 4, v2
  v_lshl_add_u32 v2, v13, 8, v2
  v_add_u32 v3, 4, v13
  v_xor_b32 v3, v3, v14
  v_lshlrev_b32 v3, 4, v3
  v_lshl_add_u32 v3, v13, 8, v3
  v_add_u32 v4, 8, v13
  v_xor_b32 v4, v4, v14
  v_lshlrev_b32 v4, 4, v4
  v_lshl_add_u32 v4, v13, 8, v4
  v_add_u32 v5, 12, v13
  v_xor_b32 v5, v5, v14
  v_lshlrev_b32 v5, 4, v5
  v_lshl_add_u32 v5, v13, 8, v5
  s_lshl_b32 s40, s2, 20
  s_waitcnt lgkmcnt(0)
  s_add_u32 s8, s4, s40
  s_addc_u32 s9, s5, 0
  s_mov_b32 s10, 1048576
  s_mov_b32 s11, 0x20000
  s_add_u32 s12, s6, s40
  s_addc_u32 s13, s7, 0
  s_mov_b32 s14, 1048576
  s_mov_b32 s15, 0x20000
  s_add_u32 s45, s44, 0
  s_add_u32 m0, s46, 0
  s_nop 0
  buffer_load_dwordx4 v2, s[8:11], s45 offen offset:0 nt lds
  buffer_load_dwordx4 v3, s[8:11], s45 offen offset:1024 nt lds
  buffer_load_dwordx4 v4, s[8:11], s45 offen offset:2048 nt lds
  buffer_load_dwordx4 v5, s[8:11], s45 offen offset:3072 nt lds
  s_add_u32 s45, s44, 4096
  s_add_u32 m0, s46, 4096
  s_nop 0
  buffer_load_dwordx4 v2, s[8:11], s45 offen offset:0 nt lds
  s_barrier
  v_lshlrev_b32 v6, 4, v0
  v_lshlrev_b32 v7, 10, v13
  v_lshl_add_u32 v7, v14, 4, v7
  v_add_u32 v8, 0, v13
  v_xor_b32 v8, v8, v14
  v_lshlrev_b32 v8, 4, v8
  v_lshl_add_u32 v8, v14, 8, v8
  v_add_u32 v8, s46, v8
  v_add_u32 v9, 4, v13
  v_xor_b32 v9, v9, v14
  v_lshlrev_b32 v9, 4, v9
  v_lshl_add_u32 v9, v14, 8, v9
  v_add_u32 v9, s46, v9
  v_add_u32 v10, 8, v13
  v_xor_b32 v10, v10, v14
  v_lshlrev_b32 v10, 4, v10
  v_lshl_add_u32 v10, v14, 8, v10
  v_add_u32 v10, s46, v10
  v_add_u32 v11, 12, v13
  v_xor_b32 v11, v11, v14
  v_lshlrev_b32 v11, 4, v11
  v_lshl_add_u32 v11, v14, 8, v11
  v_add_u32 v11, s46, v11
  v_add_u32 v12, s46, v7
  v_and_b32 v106, 15, v0
  v_and_b32 v107, 1, v106
  v_mov_b32 v108, 0x0c0c0100
  v_mov_b32 v109, 0x01000c0c
  v_cmp_eq_u32 vcc, 1, v107
  s_nop 1
  v_cndmask_b32 v108, v108, v109, vcc
  v_mov_b32 v109, 0x0c0c0302
  v_mov_b32 v107, 0x03020c0c
  v_cndmask_b32 v109, v109, v107, vcc
  v_lshrrev_b32 v106, 1, v106
  v_mov_b32 v107, 0x0c0c0c0c
  v_cmp_eq_u32 vcc, 0, v106
  s_nop 1
  v_cndmask_b32 v98, v107, v108, vcc
  v_cndmask_b32 v102, v107, v109, vcc
  v_cmp_eq_u32 vcc, 1, v106
  s_nop 1
  v_cndmask_b32 v99, v107, v108, vcc
  v_cndmask_b32 v103, v107, v109, vcc
  v_cmp_eq_u32 vcc, 2, v106
  s_nop 1
  v_cndmask_b32 v100, v107, v108, vcc
  v_cndmask_b32 v104, v107, v109, vcc
  v_cmp_eq_u32 vcc, 3, v106
  s_nop 1
  v_cndmask_b32 v101, v107, v108, vcc
  v_cndmask_b32 v105, v107, v109, vcc
  v_mov_b32 v90, 0xff800000
  v_mov_b32 v91, 0
  v_mov_b32 v92, 0
  v_mov_b32 v93, 0
  v_mov_b32 v94, 0
  v_mov_b32 v95, 0
  s_mov_b32 s48, 0x3fb8aa3b
  s_mov_b32 s80, 0xffff0000
  s_mov_b32 s81, 0x3db504f3
  s_waitcnt vmcnt(4)
  buffer_load_dwordx4 v3, s[8:11], s45 offen offset:1024 nt lds
  s_waitcnt vmcnt(4)
  buffer_load_dwordx4 v4, s[8:11], s45 offen offset:2048 nt lds
  s_waitcnt vmcnt(4)
  buffer_load_dwordx4 v5, s[8:11], s45 offen offset:3072 nt lds
  s_add_u32 s45, s44, 32768
  s_add_u32 m0, s46, 8192
  s_waitcnt vmcnt(4)
  buffer_load_dwordx4 v2, s[8:11], s45 offen offset:0 nt lds
  s_waitcnt vmcnt(4)
  buffer_load_dwordx4 v3, s[8:11], s45 offen offset:1024 nt lds
  s_waitcnt vmcnt(4)
  buffer_load_dwordx4 v4, s[8:11], s45 offen offset:2048 nt lds
  s_waitcnt vmcnt(4)
  buffer_load_dwordx4 v5, s[8:11], s45 offen offset:3072 nt lds
  s_add_u32 s45, s44, 36864
  s_add_u32 m0, s46, 12288
  s_waitcnt vmcnt(4)
  buffer_load_dwordx4 v2, s[8:11], s45 offen offset:0 nt lds
  s_waitcnt vmcnt(4)
  buffer_load_dwordx4 v3, s[8:11], s45 offen offset:1024 nt lds
  s_waitcnt vmcnt(4)
  buffer_load_dwordx4 v4, s[8:11], s45 offen offset:2048 nt lds
  s_waitcnt vmcnt(4)
  buffer_load_dwordx4 v5, s[8:11], s45 offen offset:3072 nt lds
  s_add_u32 s45, s44, 65536
  s_add_u32 m0, s46, 16384
  s_waitcnt vmcnt(4)
  buffer_load_dwordx4 v2, s[8:11], s45 offen offset:0 nt lds
  s_waitcnt vmcnt(4)
  buffer_load_dwordx4 v3, s[8:11], s45 offen offset:1024 nt lds
  s_waitcnt vmcnt(4)
  buffer_load_dwordx4 v4, s[8:11], s45 offen offset:2048 nt lds
  s_waitcnt vmcnt(4)
  buffer_load_dwordx4 v5, s[8:11], s45 offen offset:3072 nt lds
  s_add_u32 s45, s44, 69632
  s_add_u32 m0, s46, 20480
  s_waitcnt vmcnt(4)
  buffer_load_dwordx4 v2, s[8:11], s45 offen offset:0 nt lds
  s_waitcnt vmcnt(4)
  buffer_load_dwordx4 v3, s[8:11], s45 offen offset:1024 nt lds
  s_waitcnt vmcnt(4)
  buffer_load_dwordx4 v4, s[8:11], s45 offen offset:2048 nt lds
  s_waitcnt vmcnt(4)
  buffer_load_dwordx4 v5, s[8:11], s45 offen offset:3072 nt lds
  s_add_u32 s45, s44, 98304
  s_add_u32 m0, s46, 24576
  s_waitcnt vmcnt(4)
  buffer_load_dwordx4 v2, s[8:11], s45 offen offset:0 nt lds
  s_waitcnt vmcnt(4)
  buffer_load_dwordx4 v3, s[8:11], s45 offen offset:1024 nt lds
  s_waitcnt vmcnt(4)
  buffer_load_dwordx4 v4, s[8:11], s45 offen offset:2048 nt lds
  s_waitcnt vmcnt(4)
  buffer_load_dwordx4 v5, s[8:11], s45 offen offset:3072 nt lds
  s_add_u32 s45, s44, 102400
  s_add_u32 m0, s46, 28672
  s_waitcnt vmcnt(4)
  buffer_load_dwordx4 v2, s[8:11], s45 offen offset:0 nt lds
  s_waitcnt vmcnt(4)
  buffer_load_dwordx4 v3, s[8:11], s45 offen offset:1024 nt lds
  s_waitcnt vmcnt(4)
  buffer_load_dwordx4 v4, s[8:11], s45 offen offset:2048 nt lds
  s_waitcnt vmcnt(4)
  buffer_load_dwordx4 v5, s[8:11], s45 offen offset:3072 nt lds
  s_add_u32 s45, s44, 0
  s_waitcnt vmcnt(4)
  buffer_load_dwordx4 v[112:115], v7, s[12:15], s45 offen offset:0 nt
  s_waitcnt vmcnt(4)
  buffer_load_dwordx4 v[116:119], v7, s[12:15], s45 offen offset:256 nt
  s_waitcnt vmcnt(4)
  buffer_load_dwordx4 v[120:123], v7, s[12:15], s45 offen offset:512 nt
  s_waitcnt vmcnt(4)
  buffer_load_dwordx4 v[124:127], v7, s[12:15], s45 offen offset:768 nt
  s_add_u32 s45, s44, 4096
  s_waitcnt vmcnt(4)
  buffer_load_dwordx4 v[128:131], v7, s[12:15], s45 offen offset:0 nt
  s_waitcnt vmcnt(4)
  buffer_load_dwordx4 v[132:135], v7, s[12:15], s45 offen offset:256 nt
  s_waitcnt vmcnt(4)
  buffer_load_dwordx4 v[136:139], v7, s[12:15], s45 offen offset:512 nt
  s_waitcnt vmcnt(4)
  buffer_load_dwordx4 v[140:143], v7, s[12:15], s45 offen offset:768 nt
  s_add_u32 s45, s44, 32768
  s_waitcnt vmcnt(4)
  buffer_load_dwordx4 v[144:147], v7, s[12:15], s45 offen offset:0 nt
  s_waitcnt vmcnt(4)
  buffer_load_dwordx4 v[148:151], v7, s[12:15], s45 offen offset:256 nt
  s_waitcnt vmcnt(4)
  buffer_load_dwordx4 v[152:155], v7, s[12:15], s45 offen offset:512 nt
  s_waitcnt vmcnt(4)
  buffer_load_dwordx4 v[156:159], v7, s[12:15], s45 offen offset:768 nt
  s_add_u32 s45, s44, 36864
  s_waitcnt vmcnt(4)
  buffer_load_dwordx4 v[160:163], v7, s[12:15], s45 offen offset:0 nt
  s_waitcnt vmcnt(4)
  buffer_load_dwordx4 v[164:167], v7, s[12:15], s45 offen offset:256 nt
  s_waitcnt vmcnt(4)
  buffer_load_dwordx4 v[168:171], v7, s[12:15], s45 offen offset:512 nt
  s_waitcnt vmcnt(4)
  buffer_load_dwordx4 v[172:175], v7, s[12:15], s45 offen offset:768 nt
  s_add_u32 s45, s44, 65536
  s_waitcnt vmcnt(4)
  buffer_load_dwordx4 v[176:179], v7, s[12:15], s45 offen offset:0 nt
  s_waitcnt vmcnt(4)
  buffer_load_dwordx4 v[180:183], v7, s[12:15], s45 offen offset:256 nt
  s_waitcnt vmcnt(4)
  buffer_load_dwordx4 v[184:187], v7, s[12:15], s45 offen offset:512 nt
  s_waitcnt vmcnt(4)
  buffer_load_dwordx4 v[188:191], v7, s[12:15], s45 offen offset:768 nt
  s_add_u32 s45, s44, 69632
  s_waitcnt vmcnt(4)
  buffer_load_dwordx4 v[192:195], v7, s[12:15], s45 offen offset:0 nt
  s_waitcnt vmcnt(4)
  buffer_load_dwordx4 v[196:199], v7, s[12:15], s45 offen offset:256 nt
  s_waitcnt vmcnt(4)
  buffer_load_dwordx4 v[200:203], v7, s[12:15], s45 offen offset:512 nt
  s_waitcnt vmcnt(4)
  buffer_load_dwordx4 v[204:207], v7, s[12:15], s45 offen offset:768 nt
  v_mov_b32 v106, 150608
L_qwait:
  ds_read_b32 v107, v106
  s_waitcnt lgkmcnt(0)
  v_readfirstlane_b32 s40, v107
  s_nop 3
  s_cmp_ge_u32 s40, 4
  s_cbranch_scc1 L_qready
  s_sleep 1
  s_branch L_qwait
L_qready:
  v_lshlrev_b32 v106, 4, v0
  v_and_b32 v106, 0x1ff, v106
  v_add_u32 v106, 131072, v106
  ds_read_b128 v[32:35], v106 offset:0
  ds_read_b128 v[36:39], v106 offset:512
  ds_read_b128 v[40:43], v106 offset:1024
  ds_read_b128 v[44:47], v106 offset:1536
  s_add_u32 s45, s44, 98304
  s_waitcnt vmcnt(4)
  buffer_load_dwordx4 v[208:211], v7, s[12:15], s45 offen offset:0 nt
  s_waitcnt vmcnt(4)
  buffer_load_dwordx4 v[212:215], v7, s[12:15], s45 offen offset:256 nt
  s_waitcnt lgkmcnt(0)
  v_add_f32 v32, v32, v36
  v_add_f32 v40, v40, v44
  v_add_f32 v33, v33, v37
  v_add_f32 v41, v41, v45
  v_add_f32 v34, v34, v38
  v_add_f32 v42, v42, v46
  v_add_f32 v35, v35, v39
  v_add_f32 v43, v43, v47
  v_add_f32 v32, v32, v40
  v_add_f32 v33, v33, v41
  v_add_f32 v34, v34, v42
  v_add_f32 v35, v35, v43
  v_cvt_pk_bf16_f32 v36, v32, v33
  v_cvt_pk_bf16_f32 v37, v34, v35
  v_lshlrev_b32 v107, 3, v0
  v_and_b32 v107, 0xff, v107
  s_lshl_b32 s40, s3, 8
  s_add_u32 s40, s40, 133120
  v_add_u32 v107, s40, v107
  ds_write_b64 v107, v[36:37]
  v_lshrrev_b32 v108, 4, v0
  v_lshlrev_b32 v108, 4, v108
  v_add_u32 v108, s40, v108
  s_waitcnt lgkmcnt(0)
  ds_read_b128 v[16:19], v108 offset:0
  ds_read_b128 v[20:23], v108 offset:64
  ds_read_b128 v[24:27], v108 offset:128
  ds_read_b128 v[28:31], v108 offset:192
  s_waitcnt vmcnt(4)
  buffer_load_dwordx4 v[216:219], v7, s[12:15], s45 offen offset:512 nt
  s_waitcnt lgkmcnt(0)
  ds_read_b128 v[32:35], v8 offset:0
  ds_read_b128 v[36:39], v9 offset:0
  ds_read_b128 v[40:43], v10 offset:0
  ds_read_b128 v[44:47], v11 offset:0
  s_waitcnt lgkmcnt(3)
  v_mfma_f32_16x16x32_bf16 v[48:51], v[32:35], v[16:19], 0
  s_waitcnt lgkmcnt(2)
  v_mfma_f32_16x16x32_bf16 v[48:51], v[36:39], v[20:23], v[48:51]
  s_waitcnt lgkmcnt(1)
  v_mfma_f32_16x16x32_bf16 v[48:51], v[40:43], v[24:27], v[48:51]
  s_waitcnt lgkmcnt(0)
  v_mfma_f32_16x16x32_bf16 v[48:51], v[44:47], v[28:31], v[48:51]
  s_waitcnt vmcnt(4)
  buffer_load_dwordx4 v[220:223], v7, s[12:15], s45 offen offset:768 nt
  s_nop 7
  v_cvt_pk_bf16_f32 v106, v48, v49
  v_cvt_pk_bf16_f32 v107, v50, v51
  v_lshlrev_b32 v48, 16, v106
  v_and_b32 v49, s80, v106
  v_lshlrev_b32 v50, 16, v107
  v_and_b32 v51, s80, v107
  v_mul_f32 v48, s81, v48
  v_mul_f32 v49, s81, v49
  v_mul_f32 v50, s81, v50
  v_mul_f32 v51, s81, v51
  v_cvt_pk_bf16_f32 v106, v48, v49
  v_cvt_pk_bf16_f32 v107, v50, v51
  v_lshlrev_b32 v48, 16, v106
  v_and_b32 v49, s80, v106
  v_lshlrev_b32 v50, 16, v107
  v_and_b32 v51, s80, v107
  v_max3_f32 v14, v90, v48, v49
  v_max3_f32 v14, v14, v50, v51
  s_add_u32 s45, s44, 102400
  s_waitcnt vmcnt(4)
  buffer_load_dwordx4 v[224:227], v7, s[12:15], s45 offen offset:0 nt
  ds_read_b128 v[32:35], v8 offset:4096
  ds_read_b128 v[36:39], v9 offset:4096
  ds_read_b128 v[40:43], v10 offset:4096
  ds_read_b128 v[44:47], v11 offset:4096
  s_waitcnt lgkmcnt(3)
  v_mfma_f32_16x16x32_bf16 v[52:55], v[32:35], v[16:19], 0
  s_waitcnt lgkmcnt(2)
  v_mfma_f32_16x16x32_bf16 v[52:55], v[36:39], v[20:23], v[52:55]
  s_waitcnt lgkmcnt(1)
  v_mfma_f32_16x16x32_bf16 v[52:55], v[40:43], v[24:27], v[52:55]
  s_waitcnt lgkmcnt(0)
  v_mfma_f32_16x16x32_bf16 v[52:55], v[44:47], v[28:31], v[52:55]
  s_waitcnt vmcnt(4)
  buffer_load_dwordx4 v[228:231], v7, s[12:15], s45 offen offset:256 nt
  s_nop 7
  v_cvt_pk_bf16_f32 v106, v52, v53
  v_cvt_pk_bf16_f32 v107, v54, v55
  v_lshlrev_b32 v52, 16, v106
  v_and_b32 v53, s80, v106
  v_lshlrev_b32 v54, 16, v107
  v_and_b32 v55, s80, v107
  v_mul_f32 v52, s81, v52
  v_mul_f32 v53, s81, v53
  v_mul_f32 v54, s81, v54
  v_mul_f32 v55, s81, v55
  v_cvt_pk_bf16_f32 v106, v52, v53
  v_cvt_pk_bf16_f32 v107, v54, v55
  v_lshlrev_b32 v52, 16, v106
  v_and_b32 v53, s80, v106
  v_lshlrev_b32 v54, 16, v107
  v_and_b32 v55, s80, v107
  v_max3_f32 v14, v14, v52, v53
  v_max3_f32 v14, v14, v54, v55
  s_waitcnt vmcnt(4)
  buffer_load_dwordx4 v[232:235], v7, s[12:15], s45 offen offset:512 nt
  ds_read_b128 v[32:35], v8 offset:8192
  ds_read_b128 v[36:39], v9 offset:8192
  ds_read_b128 v[40:43], v10 offset:8192
  ds_read_b128 v[44:47], v11 offset:8192
  s_waitcnt lgkmcnt(3)
  v_mfma_f32_16x16x32_bf16 v[56:59], v[32:35], v[16:19], 0
  s_waitcnt lgkmcnt(2)
  v_mfma_f32_16x16x32_bf16 v[56:59], v[36:39], v[20:23], v[56:59]
  s_waitcnt lgkmcnt(1)
  v_mfma_f32_16x16x32_bf16 v[56:59], v[40:43], v[24:27], v[56:59]
  s_waitcnt lgkmcnt(0)
  v_mfma_f32_16x16x32_bf16 v[56:59], v[44:47], v[28:31], v[56:59]
  s_waitcnt vmcnt(4)
  buffer_load_dwordx4 v[236:239], v7, s[12:15], s45 offen offset:768 nt
  s_add_u32 s44, s44, 131072
  s_nop 7
  v_cvt_pk_bf16_f32 v106, v56, v57
  v_cvt_pk_bf16_f32 v107, v58, v59
  v_lshlrev_b32 v56, 16, v106
  v_and_b32 v57, s80, v106
  v_lshlrev_b32 v58, 16, v107
  v_and_b32 v59, s80, v107
  v_mul_f32 v56, s81, v56
  v_mul_f32 v57, s81, v57
  v_mul_f32 v58, s81, v58
  v_mul_f32 v59, s81, v59
  v_cvt_pk_bf16_f32 v106, v56, v57
  v_cvt_pk_bf16_f32 v107, v58, v59
  v_lshlrev_b32 v56, 16, v106
  v_and_b32 v57, s80, v106
  v_lshlrev_b32 v58, 16, v107
  v_and_b32 v59, s80, v107
  v_max3_f32 v14, v14, v56, v57
  v_max3_f32 v14, v14, v58, v59
  s_add_u32 s45, s44, 0
  s_add_u32 m0, s46, 0
  s_waitcnt vmcnt(4)
  buffer_load_dwordx4 v2, s[8:11], s45 offen offset:0 nt lds
  ds_read_b128 v[32:35], v8 offset:12288
  ds_read_b128 v[36:39], v9 offset:12288
  ds_read_b128 v[40:43], v10 offset:12288
  ds_read_b128 v[44:47], v11 offset:12288
  s_waitcnt lgkmcnt(3)
  v_mfma_f32_16x16x32_bf16 v[60:63], v[32:35], v[16:19], 0
  s_waitcnt lgkmcnt(2)
  v_mfma_f32_16x16x32_bf16 v[60:63], v[36:39], v[20:23], v[60:63]
  s_waitcnt lgkmcnt(1)
  v_mfma_f32_16x16x32_bf16 v[60:63], v[40:43], v[24:27], v[60:63]
  s_waitcnt lgkmcnt(0)
  v_mfma_f32_16x16x32_bf16 v[60:63], v[44:47], v[28:31], v[60:63]
  s_waitcnt vmcnt(4)
  buffer_load_dwordx4 v3, s[8:11], s45 offen offset:1024 nt lds
  s_nop 7
  v_cvt_pk_bf16_f32 v106, v60, v61
  v_cvt_pk_bf16_f32 v107, v62, v63
  v_lshlrev_b32 v60, 16, v106
  v_and_b32 v61, s80, v106
  v_lshlrev_b32 v62, 16, v107
  v_and_b32 v63, s80, v107
  v_mul_f32 v60, s81, v60
  v_mul_f32 v61, s81, v61
  v_mul_f32 v62, s81, v62
  v_mul_f32 v63, s81, v63
  v_cvt_pk_bf16_f32 v106, v60, v61
  v_cvt_pk_bf16_f32 v107, v62, v63
  v_lshlrev_b32 v60, 16, v106
  v_and_b32 v61, s80, v106
  v_lshlrev_b32 v62, 16, v107
  v_and_b32 v63, s80, v107
  v_max3_f32 v14, v14, v60, v61
  v_max3_f32 v14, v14, v62, v63
  s_waitcnt vmcnt(4)
  buffer_load_dwordx4 v4, s[8:11], s45 offen offset:2048 nt lds
  ds_read_b128 v[32:35], v8 offset:16384
  ds_read_b128 v[36:39], v9 offset:16384
  ds_read_b128 v[40:43], v10 offset:16384
  ds_read_b128 v[44:47], v11 offset:16384
  s_waitcnt lgkmcnt(3)
  v_mfma_f32_16x16x32_bf16 v[64:67], v[32:35], v[16:19], 0
  s_waitcnt lgkmcnt(2)
  v_mfma_f32_16x16x32_bf16 v[64:67], v[36:39], v[20:23], v[64:67]
  s_waitcnt lgkmcnt(1)
  v_mfma_f32_16x16x32_bf16 v[64:67], v[40:43], v[24:27], v[64:67]
  s_waitcnt lgkmcnt(0)
  v_mfma_f32_16x16x32_bf16 v[64:67], v[44:47], v[28:31], v[64:67]
  s_waitcnt vmcnt(4)
  buffer_load_dwordx4 v5, s[8:11], s45 offen offset:3072 nt lds
  s_nop 7
  v_cvt_pk_bf16_f32 v106, v64, v65
  v_cvt_pk_bf16_f32 v107, v66, v67
  v_lshlrev_b32 v64, 16, v106
  v_and_b32 v65, s80, v106
  v_lshlrev_b32 v66, 16, v107
  v_and_b32 v67, s80, v107
  v_mul_f32 v64, s81, v64
  v_mul_f32 v65, s81, v65
  v_mul_f32 v66, s81, v66
  v_mul_f32 v67, s81, v67
  v_cvt_pk_bf16_f32 v106, v64, v65
  v_cvt_pk_bf16_f32 v107, v66, v67
  v_lshlrev_b32 v64, 16, v106
  v_and_b32 v65, s80, v106
  v_lshlrev_b32 v66, 16, v107
  v_and_b32 v67, s80, v107
  v_max3_f32 v14, v14, v64, v65
  v_max3_f32 v14, v14, v66, v67
  s_add_u32 s45, s44, 4096
  s_add_u32 m0, s46, 4096
  s_waitcnt vmcnt(4)
  buffer_load_dwordx4 v2, s[8:11], s45 offen offset:0 nt lds
  ds_read_b128 v[32:35], v8 offset:20480
  ds_read_b128 v[36:39], v9 offset:20480
  ds_read_b128 v[40:43], v10 offset:20480
  ds_read_b128 v[44:47], v11 offset:20480
  s_waitcnt lgkmcnt(3)
  v_mfma_f32_16x16x32_bf16 v[68:71], v[32:35], v[16:19], 0
  s_waitcnt lgkmcnt(2)
  v_mfma_f32_16x16x32_bf16 v[68:71], v[36:39], v[20:23], v[68:71]
  s_waitcnt lgkmcnt(1)
  v_mfma_f32_16x16x32_bf16 v[68:71], v[40:43], v[24:27], v[68:71]
  s_waitcnt lgkmcnt(0)
  v_mfma_f32_16x16x32_bf16 v[68:71], v[44:47], v[28:31], v[68:71]
  s_waitcnt vmcnt(4)
  buffer_load_dwordx4 v3, s[8:11], s45 offen offset:1024 nt lds
  s_nop 7
  v_cvt_pk_bf16_f32 v106, v68, v69
  v_cvt_pk_bf16_f32 v107, v70, v71
  v_lshlrev_b32 v68, 16, v106
  v_and_b32 v69, s80, v106
  v_lshlrev_b32 v70, 16, v107
  v_and_b32 v71, s80, v107
  v_mul_f32 v68, s81, v68
  v_mul_f32 v69, s81, v69
  v_mul_f32 v70, s81, v70
  v_mul_f32 v71, s81, v71
  v_cvt_pk_bf16_f32 v106, v68, v69
  v_cvt_pk_bf16_f32 v107, v70, v71
  v_lshlrev_b32 v68, 16, v106
  v_and_b32 v69, s80, v106
  v_lshlrev_b32 v70, 16, v107
  v_and_b32 v71, s80, v107
  v_max3_f32 v14, v14, v68, v69
  v_max3_f32 v14, v14, v70, v71
  s_waitcnt vmcnt(4)
  buffer_load_dwordx4 v4, s[8:11], s45 offen offset:2048 nt lds
  ds_read_b128 v[32:35], v8 offset:24576
  ds_read_b128 v[36:39], v9 offset:24576
  ds_read_b128 v[40:43], v10 offset:24576
  ds_read_b128 v[44:47], v11 offset:24576
  s_waitcnt lgkmcnt(3)
  v_mfma_f32_16x16x32_bf16 v[72:75], v[32:35], v[16:19], 0
  s_waitcnt lgkmcnt(2)
  v_mfma_f32_16x16x32_bf16 v[72:75], v[36:39], v[20:23], v[72:75]
  s_waitcnt lgkmcnt(1)
  v_mfma_f32_16x16x32_bf16 v[72:75], v[40:43], v[24:27], v[72:75]
  s_waitcnt lgkmcnt(0)
  v_mfma_f32_16x16x32_bf16 v[72:75], v[44:47], v[28:31], v[72:75]
  s_waitcnt vmcnt(4)
  buffer_load_dwordx4 v5, s[8:11], s45 offen offset:3072 nt lds
  s_nop 7
  v_cvt_pk_bf16_f32 v106, v72, v73
  v_cvt_pk_bf16_f32 v107, v74, v75
  v_lshlrev_b32 v72, 16, v106
  v_and_b32 v73, s80, v106
  v_lshlrev_b32 v74, 16, v107
  v_and_b32 v75, s80, v107
  v_mul_f32 v72, s81, v72
  v_mul_f32 v73, s81, v73
  v_mul_f32 v74, s81, v74
  v_mul_f32 v75, s81, v75
  v_cvt_pk_bf16_f32 v106, v72, v73
  v_cvt_pk_bf16_f32 v107, v74, v75
  v_lshlrev_b32 v72, 16, v106
  v_and_b32 v73, s80, v106
  v_lshlrev_b32 v74, 16, v107
  v_and_b32 v75, s80, v107
  v_max3_f32 v14, v14, v72, v73
  v_max3_f32 v14, v14, v74, v75
  s_add_u32 s45, s44, 32768
  s_add_u32 m0, s46, 8192
  s_waitcnt vmcnt(4)
  buffer_load_dwordx4 v2, s[8:11], s45 offen offset:0 nt lds
  ds_read_b128 v[32:35], v8 offset:28672
  ds_read_b128 v[36:39], v9 offset:28672
  ds_read_b128 v[40:43], v10 offset:28672
  ds_read_b128 v[44:47], v11 offset:28672
  s_waitcnt lgkmcnt(3)
  v_mfma_f32_16x16x32_bf16 v[76:79], v[32:35], v[16:19], 0
  s_waitcnt lgkmcnt(2)
  v_mfma_f32_16x16x32_bf16 v[76:79], v[36:39], v[20:23], v[76:79]
  s_waitcnt lgkmcnt(1)
  v_mfma_f32_16x16x32_bf16 v[76:79], v[40:43], v[24:27], v[76:79]
  s_waitcnt lgkmcnt(0)
  v_mfma_f32_16x16x32_bf16 v[76:79], v[44:47], v[28:31], v[76:79]
  s_waitcnt vmcnt(4)
  buffer_load_dwordx4 v3, s[8:11], s45 offen offset:1024 nt lds
  s_nop 7
  v_cvt_pk_bf16_f32 v106, v76, v77
  v_cvt_pk_bf16_f32 v107, v78, v79
  v_lshlrev_b32 v76, 16, v106
  v_and_b32 v77, s80, v106
  v_lshlrev_b32 v78, 16, v107
  v_and_b32 v79, s80, v107
  v_mul_f32 v76, s81, v76
  v_mul_f32 v77, s81, v77
  v_mul_f32 v78, s81, v78
  v_mul_f32 v79, s81, v79
  v_cvt_pk_bf16_f32 v106, v76, v77
  v_cvt_pk_bf16_f32 v107, v78, v79
  v_lshlrev_b32 v76, 16, v106
  v_and_b32 v77, s80, v106
  v_lshlrev_b32 v78, 16, v107
  v_and_b32 v79, s80, v107
  v_max3_f32 v14, v14, v76, v77
  v_max3_f32 v14, v14, v78, v79
  v_mov_b32 v106, v14
  s_nop 1
  v_permlane16_swap_b32 v14, v106
  s_nop 1
  v_max_f32 v14, v14, v106
  v_mov_b32 v106, v14
  s_nop 1
  v_permlane32_swap_b32 v14, v106
  s_nop 1
  v_max_f32 v14, v14, v106
  v_sub_f32 v96, v90, v14
  v_mul_f32 v97, s48, v14
  v_mul_f32 v96, s48, v96
  v_mov_b32 v90, v14
  v_exp_f32 v96, v96
  s_nop 0
  v_mul_f32 v92, v92, v96
  v_mul_f32 v93, v93, v96
  v_mul_f32 v94, v94, v96
  v_mul_f32 v95, v95, v96
  v_mul_f32 v91, v91, v96
  s_waitcnt vmcnt(4)
  buffer_load_dwordx4 v4, s[8:11], s45 offen offset:2048 nt lds
  v_fma_f32 v48, v48, s48, -v97
  v_fma_f32 v49, v49, s48, -v97
  v_fma_f32 v50, v50, s48, -v97
  v_fma_f32 v51, v51, s48, -v97
  v_exp_f32 v48, v48
  v_exp_f32 v49, v49
  v_exp_f32 v50, v50
  v_exp_f32 v51, v51
  s_nop 0
  v_cvt_pk_bf16_f32 v80, v48, v49
  v_cvt_pk_bf16_f32 v81, v50, v51
  v_add_f32 v106, v48, v49
  v_add_f32 v107, v50, v51
  v_add_f32 v91, v91, v106
  v_add_f32 v91, v91, v107
  v_perm_b32 v82, v80, v80, v98
  v_perm_b32 v83, v80, v80, v99
  v_perm_b32 v84, v80, v80, v100
  v_perm_b32 v85, v80, v80, v101
  s_nop 1
  v_mfma_f32_16x16x32_bf16 v[92:95], v[82:85], v[112:115], v[92:95]
  v_perm_b32 v86, v80, v80, v102
  v_perm_b32 v87, v80, v80, v103
  v_perm_b32 v88, v80, v80, v104
  v_perm_b32 v89, v80, v80, v105
  s_nop 1
  v_mfma_f32_16x16x32_bf16 v[92:95], v[86:89], v[116:119], v[92:95]
  s_waitcnt vmcnt(4)
  buffer_load_dwordx4 v5, s[8:11], s45 offen offset:3072 nt lds
  v_perm_b32 v82, v81, v81, v98
  v_perm_b32 v83, v81, v81, v99
  v_perm_b32 v84, v81, v81, v100
  v_perm_b32 v85, v81, v81, v101
  s_nop 1
  v_mfma_f32_16x16x32_bf16 v[92:95], v[82:85], v[120:123], v[92:95]
  v_perm_b32 v86, v81, v81, v102
  v_perm_b32 v87, v81, v81, v103
  v_perm_b32 v88, v81, v81, v104
  v_perm_b32 v89, v81, v81, v105
  s_nop 1
  v_mfma_f32_16x16x32_bf16 v[92:95], v[86:89], v[124:127], v[92:95]
  s_add_u32 s45, s44, 36864
  s_add_u32 m0, s46, 12288
  s_waitcnt vmcnt(4)
  buffer_load_dwordx4 v2, s[8:11], s45 offen offset:0 nt lds
  v_fma_f32 v52, v52, s48, -v97
  v_fma_f32 v53, v53, s48, -v97
  v_fma_f32 v54, v54, s48, -v97
  v_fma_f32 v55, v55, s48, -v97
  v_exp_f32 v52, v52
  v_exp_f32 v53, v53
  v_exp_f32 v54, v54
  v_exp_f32 v55, v55
  s_nop 0
  v_cvt_pk_bf16_f32 v80, v52, v53
  v_cvt_pk_bf16_f32 v81, v54, v55
  v_add_f32 v106, v52, v53
  v_add_f32 v107, v54, v55
  v_add_f32 v91, v91, v106
  v_add_f32 v91, v91, v107
  v_perm_b32 v82, v80, v80, v98
  v_perm_b32 v83, v80, v80, v99
  v_perm_b32 v84, v80, v80, v100
  v_perm_b32 v85, v80, v80, v101
  s_nop 1
  v_mfma_f32_16x16x32_bf16 v[92:95], v[82:85], v[128:131], v[92:95]
  v_perm_b32 v86, v80, v80, v102
  v_perm_b32 v87, v80, v80, v103
  v_perm_b32 v88, v80, v80, v104
  v_perm_b32 v89, v80, v80, v105
  s_nop 1
  v_mfma_f32_16x16x32_bf16 v[92:95], v[86:89], v[132:135], v[92:95]
  s_waitcnt vmcnt(4)
  buffer_load_dwordx4 v3, s[8:11], s45 offen offset:1024 nt lds
  v_perm_b32 v82, v81, v81, v98
  v_perm_b32 v83, v81, v81, v99
  v_perm_b32 v84, v81, v81, v100
  v_perm_b32 v85, v81, v81, v101
  s_nop 1
  v_mfma_f32_16x16x32_bf16 v[92:95], v[82:85], v[136:139], v[92:95]
  v_perm_b32 v86, v81, v81, v102
  v_perm_b32 v87, v81, v81, v103
  v_perm_b32 v88, v81, v81, v104
  v_perm_b32 v89, v81, v81, v105
  s_nop 1
  v_mfma_f32_16x16x32_bf16 v[92:95], v[86:89], v[140:143], v[92:95]
  s_waitcnt vmcnt(4)
  buffer_load_dwordx4 v4, s[8:11], s45 offen offset:2048 nt lds
  v_fma_f32 v56, v56, s48, -v97
  v_fma_f32 v57, v57, s48, -v97
  v_fma_f32 v58, v58, s48, -v97
  v_fma_f32 v59, v59, s48, -v97
  v_exp_f32 v56, v56
  v_exp_f32 v57, v57
  v_exp_f32 v58, v58
  v_exp_f32 v59, v59
  s_nop 0
  v_cvt_pk_bf16_f32 v80, v56, v57
  v_cvt_pk_bf16_f32 v81, v58, v59
  v_add_f32 v106, v56, v57
  v_add_f32 v107, v58, v59
  v_add_f32 v91, v91, v106
  v_add_f32 v91, v91, v107
  v_perm_b32 v82, v80, v80, v98
  v_perm_b32 v83, v80, v80, v99
  v_perm_b32 v84, v80, v80, v100
  v_perm_b32 v85, v80, v80, v101
  s_nop 1
  v_mfma_f32_16x16x32_bf16 v[92:95], v[82:85], v[144:147], v[92:95]
  v_perm_b32 v86, v80, v80, v102
  v_perm_b32 v87, v80, v80, v103
  v_perm_b32 v88, v80, v80, v104
  v_perm_b32 v89, v80, v80, v105
  s_nop 1
  v_mfma_f32_16x16x32_bf16 v[92:95], v[86:89], v[148:151], v[92:95]
  s_waitcnt vmcnt(4)
  buffer_load_dwordx4 v5, s[8:11], s45 offen offset:3072 nt lds
  v_perm_b32 v82, v81, v81, v98
  v_perm_b32 v83, v81, v81, v99
  v_perm_b32 v84, v81, v81, v100
  v_perm_b32 v85, v81, v81, v101
  s_nop 1
  v_mfma_f32_16x16x32_bf16 v[92:95], v[82:85], v[152:155], v[92:95]
  v_perm_b32 v86, v81, v81, v102
  v_perm_b32 v87, v81, v81, v103
  v_perm_b32 v88, v81, v81, v104
  v_perm_b32 v89, v81, v81, v105
  s_nop 1
  v_mfma_f32_16x16x32_bf16 v[92:95], v[86:89], v[156:159], v[92:95]
  s_add_u32 s45, s44, 65536
  s_add_u32 m0, s46, 16384
  s_waitcnt vmcnt(4)
  buffer_load_dwordx4 v2, s[8:11], s45 offen offset:0 nt lds
  v_fma_f32 v60, v60, s48, -v97
  v_fma_f32 v61, v61, s48, -v97
  v_fma_f32 v62, v62, s48, -v97
  v_fma_f32 v63, v63, s48, -v97
  v_exp_f32 v60, v60
  v_exp_f32 v61, v61
  v_exp_f32 v62, v62
  v_exp_f32 v63, v63
  s_nop 0
  v_cvt_pk_bf16_f32 v80, v60, v61
  v_cvt_pk_bf16_f32 v81, v62, v63
  v_add_f32 v106, v60, v61
  v_add_f32 v107, v62, v63
  v_add_f32 v91, v91, v106
  v_add_f32 v91, v91, v107
  v_perm_b32 v82, v80, v80, v98
  v_perm_b32 v83, v80, v80, v99
  v_perm_b32 v84, v80, v80, v100
  v_perm_b32 v85, v80, v80, v101
  s_nop 1
  v_mfma_f32_16x16x32_bf16 v[92:95], v[82:85], v[160:163], v[92:95]
  v_perm_b32 v86, v80, v80, v102
  v_perm_b32 v87, v80, v80, v103
  v_perm_b32 v88, v80, v80, v104
  v_perm_b32 v89, v80, v80, v105
  s_nop 1
  v_mfma_f32_16x16x32_bf16 v[92:95], v[86:89], v[164:167], v[92:95]
  s_waitcnt vmcnt(4)
  buffer_load_dwordx4 v3, s[8:11], s45 offen offset:1024 nt lds
  v_perm_b32 v82, v81, v81, v98
  v_perm_b32 v83, v81, v81, v99
  v_perm_b32 v84, v81, v81, v100
  v_perm_b32 v85, v81, v81, v101
  s_nop 1
  v_mfma_f32_16x16x32_bf16 v[92:95], v[82:85], v[168:171], v[92:95]
  v_perm_b32 v86, v81, v81, v102
  v_perm_b32 v87, v81, v81, v103
  v_perm_b32 v88, v81, v81, v104
  v_perm_b32 v89, v81, v81, v105
  s_nop 1
  v_mfma_f32_16x16x32_bf16 v[92:95], v[86:89], v[172:175], v[92:95]
  s_waitcnt vmcnt(4)
  buffer_load_dwordx4 v4, s[8:11], s45 offen offset:2048 nt lds
  v_fma_f32 v64, v64, s48, -v97
  v_fma_f32 v65, v65, s48, -v97
  v_fma_f32 v66, v66, s48, -v97
  v_fma_f32 v67, v67, s48, -v97
  v_exp_f32 v64, v64
  v_exp_f32 v65, v65
  v_exp_f32 v66, v66
  v_exp_f32 v67, v67
  s_nop 0
  v_cvt_pk_bf16_f32 v80, v64, v65
  v_cvt_pk_bf16_f32 v81, v66, v67
  v_add_f32 v106, v64, v65
  v_add_f32 v107, v66, v67
  v_add_f32 v91, v91, v106
  v_add_f32 v91, v91, v107
  v_perm_b32 v82, v80, v80, v98
  v_perm_b32 v83, v80, v80, v99
  v_perm_b32 v84, v80, v80, v100
  v_perm_b32 v85, v80, v80, v101
  s_nop 1
  v_mfma_f32_16x16x32_bf16 v[92:95], v[82:85], v[176:179], v[92:95]
  v_perm_b32 v86, v80, v80, v102
  v_perm_b32 v87, v80, v80, v103
  v_perm_b32 v88, v80, v80, v104
  v_perm_b32 v89, v80, v80, v105
  s_nop 1
  v_mfma_f32_16x16x32_bf16 v[92:95], v[86:89], v[180:183], v[92:95]
  s_waitcnt vmcnt(4)
  buffer_load_dwordx4 v5, s[8:11], s45 offen offset:3072 nt lds
  v_perm_b32 v82, v81, v81, v98
  v_perm_b32 v83, v81, v81, v99
  v_perm_b32 v84, v81, v81, v100
  v_perm_b32 v85, v81, v81, v101
  s_nop 1
  v_mfma_f32_16x16x32_bf16 v[92:95], v[82:85], v[184:187], v[92:95]
  v_perm_b32 v86, v81, v81, v102
  v_perm_b32 v87, v81, v81, v103
  v_perm_b32 v88, v81, v81, v104
  v_perm_b32 v89, v81, v81, v105
  s_nop 1
  v_mfma_f32_16x16x32_bf16 v[92:95], v[86:89], v[188:191], v[92:95]
  s_add_u32 s45, s44, 69632
  s_add_u32 m0, s46, 20480
  s_waitcnt vmcnt(4)
  buffer_load_dwordx4 v2, s[8:11], s45 offen offset:0 nt lds
  v_fma_f32 v68, v68, s48, -v97
  v_fma_f32 v69, v69, s48, -v97
  v_fma_f32 v70, v70, s48, -v97
  v_fma_f32 v71, v71, s48, -v97
  v_exp_f32 v68, v68
  v_exp_f32 v69, v69
  v_exp_f32 v70, v70
  v_exp_f32 v71, v71
  s_nop 0
  v_cvt_pk_bf16_f32 v80, v68, v69
  v_cvt_pk_bf16_f32 v81, v70, v71
  v_add_f32 v106, v68, v69
  v_add_f32 v107, v70, v71
  v_add_f32 v91, v91, v106
  v_add_f32 v91, v91, v107
  v_perm_b32 v82, v80, v80, v98
  v_perm_b32 v83, v80, v80, v99
  v_perm_b32 v84, v80, v80, v100
  v_perm_b32 v85, v80, v80, v101
  s_nop 1
  v_mfma_f32_16x16x32_bf16 v[92:95], v[82:85], v[192:195], v[92:95]
  v_perm_b32 v86, v80, v80, v102
  v_perm_b32 v87, v80, v80, v103
  v_perm_b32 v88, v80, v80, v104
  v_perm_b32 v89, v80, v80, v105
  s_nop 1
  v_mfma_f32_16x16x32_bf16 v[92:95], v[86:89], v[196:199], v[92:95]
  s_waitcnt vmcnt(4)
  buffer_load_dwordx4 v3, s[8:11], s45 offen offset:1024 nt lds
  v_perm_b32 v82, v81, v81, v98
  v_perm_b32 v83, v81, v81, v99
  v_perm_b32 v84, v81, v81, v100
  v_perm_b32 v85, v81, v81, v101
  s_nop 1
  v_mfma_f32_16x16x32_bf16 v[92:95], v[82:85], v[200:203], v[92:95]
  v_perm_b32 v86, v81, v81, v102
  v_perm_b32 v87, v81, v81, v103
  v_perm_b32 v88, v81, v81, v104
  v_perm_b32 v89, v81, v81, v105
  s_nop 1
  v_mfma_f32_16x16x32_bf16 v[92:95], v[86:89], v[204:207], v[92:95]
  s_waitcnt vmcnt(4)
  buffer_load_dwordx4 v4, s[8:11], s45 offen offset:2048 nt lds
  v_fma_f32 v72, v72, s48, -v97
  v_fma_f32 v73, v73, s48, -v97
  v_fma_f32 v74, v74, s48, -v97
  v_fma_f32 v75, v75, s48, -v97
  v_exp_f32 v72, v72
  v_exp_f32 v73, v73
  v_exp_f32 v74, v74
  v_exp_f32 v75, v75
  s_nop 0
  v_cvt_pk_bf16_f32 v80, v72, v73
  v_cvt_pk_bf16_f32 v81, v74, v75
  v_add_f32 v106, v72, v73
  v_add_f32 v107, v74, v75
  v_add_f32 v91, v91, v106
  v_add_f32 v91, v91, v107
  v_perm_b32 v82, v80, v80, v98
  v_perm_b32 v83, v80, v80, v99
  v_perm_b32 v84, v80, v80, v100
  v_perm_b32 v85, v80, v80, v101
  s_nop 1
  v_mfma_f32_16x16x32_bf16 v[92:95], v[82:85], v[208:211], v[92:95]
  v_perm_b32 v86, v80, v80, v102
  v_perm_b32 v87, v80, v80, v103
  v_perm_b32 v88, v80, v80, v104
  v_perm_b32 v89, v80, v80, v105
  s_nop 1
  v_mfma_f32_16x16x32_bf16 v[92:95], v[86:89], v[212:215], v[92:95]
  s_waitcnt vmcnt(4)
  buffer_load_dwordx4 v5, s[8:11], s45 offen offset:3072 nt lds
  v_perm_b32 v82, v81, v81, v98
  v_perm_b32 v83, v81, v81, v99
  v_perm_b32 v84, v81, v81, v100
  v_perm_b32 v85, v81, v81, v101
  s_nop 1
  v_mfma_f32_16x16x32_bf16 v[92:95], v[82:85], v[216:219], v[92:95]
  v_perm_b32 v86, v81, v81, v102
  v_perm_b32 v87, v81, v81, v103
  v_perm_b32 v88, v81, v81, v104
  v_perm_b32 v89, v81, v81, v105
  s_nop 1
  v_mfma_f32_16x16x32_bf16 v[92:95], v[86:89], v[220:223], v[92:95]
  s_add_u32 s45, s44, 98304
  s_add_u32 m0, s46, 24576
  s_waitcnt vmcnt(4)
  buffer_load_dwordx4 v2, s[8:11], s45 offen offset:0 nt lds
  v_fma_f32 v76, v76, s48, -v97
  v_fma_f32 v77, v77, s48, -v97
  v_fma_f32 v78, v78, s48, -v97
  v_fma_f32 v79, v79, s48, -v97
  v_exp_f32 v76, v76
  v_exp_f32 v77, v77
  v_exp_f32 v78, v78
  v_exp_f32 v79, v79
  s_nop 0
  v_cvt_pk_bf16_f32 v80, v76, v77
  v_cvt_pk_bf16_f32 v81, v78, v79
  v_add_f32 v106, v76, v77
  v_add_f32 v107, v78, v79
  v_add_f32 v91, v91, v106
  v_add_f32 v91, v91, v107
  v_perm_b32 v82, v80, v80, v98
  v_perm_b32 v83, v80, v80, v99
  v_perm_b32 v84, v80, v80, v100
  v_perm_b32 v85, v80, v80, v101
  s_nop 1
  v_mfma_f32_16x16x32_bf16 v[92:95], v[82:85], v[224:227], v[92:95]
  v_perm_b32 v86, v80, v80, v102
  v_perm_b32 v87, v80, v80, v103
  v_perm_b32 v88, v80, v80, v104
  v_perm_b32 v89, v80, v80, v105
  s_nop 1
  v_mfma_f32_16x16x32_bf16 v[92:95], v[86:89], v[228:231], v[92:95]
  s_waitcnt vmcnt(4)
  buffer_load_dwordx4 v3, s[8:11], s45 offen offset:1024 nt lds
  v_perm_b32 v82, v81, v81, v98
  v_perm_b32 v83, v81, v81, v99
  v_perm_b32 v84, v81, v81, v100
  v_perm_b32 v85, v81, v81, v101
  s_nop 1
  v_mfma_f32_16x16x32_bf16 v[92:95], v[82:85], v[232:235], v[92:95]
  v_perm_b32 v86, v81, v81, v102
  v_perm_b32 v87, v81, v81, v103
  v_perm_b32 v88, v81, v81, v104
  v_perm_b32 v89, v81, v81, v105
  s_nop 1
  v_mfma_f32_16x16x32_bf16 v[92:95], v[86:89], v[236:239], v[92:95]
  s_waitcnt vmcnt(4)
  buffer_load_dwordx4 v4, s[8:11], s45 offen offset:2048 nt lds
  ds_read_b128 v[32:35], v8 offset:0
  ds_read_b128 v[36:39], v9 offset:0
  ds_read_b128 v[40:43], v10 offset:0
  ds_read_b128 v[44:47], v11 offset:0
  s_waitcnt lgkmcnt(3)
  v_mfma_f32_16x16x32_bf16 v[48:51], v[32:35], v[16:19], 0
  s_waitcnt lgkmcnt(2)
  v_mfma_f32_16x16x32_bf16 v[48:51], v[36:39], v[20:23], v[48:51]
  s_waitcnt lgkmcnt(1)
  v_mfma_f32_16x16x32_bf16 v[48:51], v[40:43], v[24:27], v[48:51]
  s_waitcnt lgkmcnt(0)
  v_mfma_f32_16x16x32_bf16 v[48:51], v[44:47], v[28:31], v[48:51]
  s_waitcnt vmcnt(4)
  buffer_load_dwordx4 v5, s[8:11], s45 offen offset:3072 nt lds
  s_nop 7
  v_cvt_pk_bf16_f32 v106, v48, v49
  v_cvt_pk_bf16_f32 v107, v50, v51
  v_lshlrev_b32 v48, 16, v106
  v_and_b32 v49, s80, v106
  v_lshlrev_b32 v50, 16, v107
  v_and_b32 v51, s80, v107
  v_mul_f32 v48, s81, v48
  v_mul_f32 v49, s81, v49
  v_mul_f32 v50, s81, v50
  v_mul_f32 v51, s81, v51
  v_cvt_pk_bf16_f32 v106, v48, v49
  v_cvt_pk_bf16_f32 v107, v50, v51
  v_lshlrev_b32 v48, 16, v106
  v_and_b32 v49, s80, v106
  v_lshlrev_b32 v50, 16, v107
  v_and_b32 v51, s80, v107
  v_max3_f32 v14, v90, v48, v49
  v_max3_f32 v14, v14, v50, v51
  s_add_u32 s45, s44, 102400
  s_add_u32 m0, s46, 28672
  s_waitcnt vmcnt(4)
  buffer_load_dwordx4 v2, s[8:11], s45 offen offset:0 nt lds
  ds_read_b128 v[32:35], v8 offset:4096
  ds_read_b128 v[36:39], v9 offset:4096
  ds_read_b128 v[40:43], v10 offset:4096
  ds_read_b128 v[44:47], v11 offset:4096
  s_waitcnt lgkmcnt(3)
  v_mfma_f32_16x16x32_bf16 v[52:55], v[32:35], v[16:19], 0
  s_waitcnt lgkmcnt(2)
  v_mfma_f32_16x16x32_bf16 v[52:55], v[36:39], v[20:23], v[52:55]
  s_waitcnt lgkmcnt(1)
  v_mfma_f32_16x16x32_bf16 v[52:55], v[40:43], v[24:27], v[52:55]
  s_waitcnt lgkmcnt(0)
  v_mfma_f32_16x16x32_bf16 v[52:55], v[44:47], v[28:31], v[52:55]
  s_waitcnt vmcnt(4)
  buffer_load_dwordx4 v3, s[8:11], s45 offen offset:1024 nt lds
  s_nop 7
  v_cvt_pk_bf16_f32 v106, v52, v53
  v_cvt_pk_bf16_f32 v107, v54, v55
  v_lshlrev_b32 v52, 16, v106
  v_and_b32 v53, s80, v106
  v_lshlrev_b32 v54, 16, v107
  v_and_b32 v55, s80, v107
  v_mul_f32 v52, s81, v52
  v_mul_f32 v53, s81, v53
  v_mul_f32 v54, s81, v54
  v_mul_f32 v55, s81, v55
  v_cvt_pk_bf16_f32 v106, v52, v53
  v_cvt_pk_bf16_f32 v107, v54, v55
  v_lshlrev_b32 v52, 16, v106
  v_and_b32 v53, s80, v106
  v_lshlrev_b32 v54, 16, v107
  v_and_b32 v55, s80, v107
  v_max3_f32 v14, v14, v52, v53
  v_max3_f32 v14, v14, v54, v55
  s_waitcnt vmcnt(4)
  buffer_load_dwordx4 v4, s[8:11], s45 offen offset:2048 nt lds
  ds_read_b128 v[32:35], v8 offset:8192
  ds_read_b128 v[36:39], v9 offset:8192
  ds_read_b128 v[40:43], v10 offset:8192
  ds_read_b128 v[44:47], v11 offset:8192
  s_waitcnt lgkmcnt(3)
  v_mfma_f32_16x16x32_bf16 v[56:59], v[32:35], v[16:19], 0
  s_waitcnt lgkmcnt(2)
  v_mfma_f32_16x16x32_bf16 v[56:59], v[36:39], v[20:23], v[56:59]
  s_waitcnt lgkmcnt(1)
  v_mfma_f32_16x16x32_bf16 v[56:59], v[40:43], v[24:27], v[56:59]
  s_waitcnt lgkmcnt(0)
  v_mfma_f32_16x16x32_bf16 v[56:59], v[44:47], v[28:31], v[56:59]
  s_waitcnt vmcnt(4)
  buffer_load_dwordx4 v5, s[8:11], s45 offen offset:3072 nt lds
  s_nop 7
  v_cvt_pk_bf16_f32 v106, v56, v57
  v_cvt_pk_bf16_f32 v107, v58, v59
  v_lshlrev_b32 v56, 16, v106
  v_and_b32 v57, s80, v106
  v_lshlrev_b32 v58, 16, v107
  v_and_b32 v59, s80, v107
  v_mul_f32 v56, s81, v56
  v_mul_f32 v57, s81, v57
  v_mul_f32 v58, s81, v58
  v_mul_f32 v59, s81, v59
  v_cvt_pk_bf16_f32 v106, v56, v57
  v_cvt_pk_bf16_f32 v107, v58, v59
  v_lshlrev_b32 v56, 16, v106
  v_and_b32 v57, s80, v106
  v_lshlrev_b32 v58, 16, v107
  v_and_b32 v59, s80, v107
  v_max3_f32 v14, v14, v56, v57
  v_max3_f32 v14, v14, v58, v59
  s_add_u32 s45, s44, 0
  s_add_u32 m0, s46, 0
  s_waitcnt vmcnt(4)
  buffer_load_dwordx4 v6, s[12:15], s45 offen offset:0 nt lds
  ds_read_b128 v[32:35], v8 offset:12288
  ds_read_b128 v[36:39], v9 offset:12288
  ds_read_b128 v[40:43], v10 offset:12288
  ds_read_b128 v[44:47], v11 offset:12288
  s_waitcnt lgkmcnt(3)
  v_mfma_f32_16x16x32_bf16 v[60:63], v[32:35], v[16:19], 0
  s_waitcnt lgkmcnt(2)
  v_mfma_f32_16x16x32_bf16 v[60:63], v[36:39], v[20:23], v[60:63]
  s_waitcnt lgkmcnt(1)
  v_mfma_f32_16x16x32_bf16 v[60:63], v[40:43], v[24:27], v[60:63]
  s_waitcnt lgkmcnt(0)
  v_mfma_f32_16x16x32_bf16 v[60:63], v[44:47], v[28:31], v[60:63]
  s_waitcnt vmcnt(4)
  buffer_load_dwordx4 v6, s[12:15], s45 offen offset:1024 nt lds
  s_nop 7
  v_cvt_pk_bf16_f32 v106, v60, v61
  v_cvt_pk_bf16_f32 v107, v62, v63
  v_lshlrev_b32 v60, 16, v106
  v_and_b32 v61, s80, v106
  v_lshlrev_b32 v62, 16, v107
  v_and_b32 v63, s80, v107
  v_mul_f32 v60, s81, v60
  v_mul_f32 v61, s81, v61
  v_mul_f32 v62, s81, v62
  v_mul_f32 v63, s81, v63
  v_cvt_pk_bf16_f32 v106, v60, v61
  v_cvt_pk_bf16_f32 v107, v62, v63
  v_lshlrev_b32 v60, 16, v106
  v_and_b32 v61, s80, v106
  v_lshlrev_b32 v62, 16, v107
  v_and_b32 v63, s80, v107
  v_max3_f32 v14, v14, v60, v61
  v_max3_f32 v14, v14, v62, v63
  s_waitcnt vmcnt(4)
  buffer_load_dwordx4 v6, s[12:15], s45 offen offset:2048 nt lds
  ds_read_b128 v[32:35], v8 offset:16384
  ds_read_b128 v[36:39], v9 offset:16384
  ds_read_b128 v[40:43], v10 offset:16384
  ds_read_b128 v[44:47], v11 offset:16384
  s_waitcnt lgkmcnt(3)
  v_mfma_f32_16x16x32_bf16 v[64:67], v[32:35], v[16:19], 0
  s_waitcnt lgkmcnt(2)
  v_mfma_f32_16x16x32_bf16 v[64:67], v[36:39], v[20:23], v[64:67]
  s_waitcnt lgkmcnt(1)
  v_mfma_f32_16x16x32_bf16 v[64:67], v[40:43], v[24:27], v[64:67]
  s_waitcnt lgkmcnt(0)
  v_mfma_f32_16x16x32_bf16 v[64:67], v[44:47], v[28:31], v[64:67]
  s_waitcnt vmcnt(4)
  buffer_load_dwordx4 v6, s[12:15], s45 offen offset:3072 nt lds
  s_nop 7
  v_cvt_pk_bf16_f32 v106, v64, v65
  v_cvt_pk_bf16_f32 v107, v66, v67
  v_lshlrev_b32 v64, 16, v106
  v_and_b32 v65, s80, v106
  v_lshlrev_b32 v66, 16, v107
  v_and_b32 v67, s80, v107
  v_mul_f32 v64, s81, v64
  v_mul_f32 v65, s81, v65
  v_mul_f32 v66, s81, v66
  v_mul_f32 v67, s81, v67
  v_cvt_pk_bf16_f32 v106, v64, v65
  v_cvt_pk_bf16_f32 v107, v66, v67
  v_lshlrev_b32 v64, 16, v106
  v_and_b32 v65, s80, v106
  v_lshlrev_b32 v66, 16, v107
  v_and_b32 v67, s80, v107
  v_max3_f32 v14, v14, v64, v65
  v_max3_f32 v14, v14, v66, v67
  s_add_u32 s45, s44, 4096
  s_add_u32 m0, s46, 4096
  s_waitcnt vmcnt(4)
  buffer_load_dwordx4 v6, s[12:15], s45 offen offset:0 nt lds
  ds_read_b128 v[32:35], v8 offset:20480
  ds_read_b128 v[36:39], v9 offset:20480
  ds_read_b128 v[40:43], v10 offset:20480
  ds_read_b128 v[44:47], v11 offset:20480
  s_waitcnt lgkmcnt(3)
  v_mfma_f32_16x16x32_bf16 v[68:71], v[32:35], v[16:19], 0
  s_waitcnt lgkmcnt(2)
  v_mfma_f32_16x16x32_bf16 v[68:71], v[36:39], v[20:23], v[68:71]
  s_waitcnt lgkmcnt(1)
  v_mfma_f32_16x16x32_bf16 v[68:71], v[40:43], v[24:27], v[68:71]
  s_waitcnt lgkmcnt(0)
  v_mfma_f32_16x16x32_bf16 v[68:71], v[44:47], v[28:31], v[68:71]
  s_waitcnt vmcnt(4)
  buffer_load_dwordx4 v6, s[12:15], s45 offen offset:1024 nt lds
  s_nop 7
  v_cvt_pk_bf16_f32 v106, v68, v69
  v_cvt_pk_bf16_f32 v107, v70, v71
  v_lshlrev_b32 v68, 16, v106
  v_and_b32 v69, s80, v106
  v_lshlrev_b32 v70, 16, v107
  v_and_b32 v71, s80, v107
  v_mul_f32 v68, s81, v68
  v_mul_f32 v69, s81, v69
  v_mul_f32 v70, s81, v70
  v_mul_f32 v71, s81, v71
  v_cvt_pk_bf16_f32 v106, v68, v69
  v_cvt_pk_bf16_f32 v107, v70, v71
  v_lshlrev_b32 v68, 16, v106
  v_and_b32 v69, s80, v106
  v_lshlrev_b32 v70, 16, v107
  v_and_b32 v71, s80, v107
  v_max3_f32 v14, v14, v68, v69
  v_max3_f32 v14, v14, v70, v71
  s_waitcnt vmcnt(4)
  buffer_load_dwordx4 v6, s[12:15], s45 offen offset:2048 nt lds
  ds_read_b128 v[32:35], v8 offset:24576
  ds_read_b128 v[36:39], v9 offset:24576
  ds_read_b128 v[40:43], v10 offset:24576
  ds_read_b128 v[44:47], v11 offset:24576
  s_waitcnt lgkmcnt(3)
  v_mfma_f32_16x16x32_bf16 v[72:75], v[32:35], v[16:19], 0
  s_waitcnt lgkmcnt(2)
  v_mfma_f32_16x16x32_bf16 v[72:75], v[36:39], v[20:23], v[72:75]
  s_waitcnt lgkmcnt(1)
  v_mfma_f32_16x16x32_bf16 v[72:75], v[40:43], v[24:27], v[72:75]
  s_waitcnt lgkmcnt(0)
  v_mfma_f32_16x16x32_bf16 v[72:75], v[44:47], v[28:31], v[72:75]
  s_waitcnt vmcnt(4)
  buffer_load_dwordx4 v6, s[12:15], s45 offen offset:3072 nt lds
  s_nop 7
  v_cvt_pk_bf16_f32 v106, v72, v73
  v_cvt_pk_bf16_f32 v107, v74, v75
  v_lshlrev_b32 v72, 16, v106
  v_and_b32 v73, s80, v106
  v_lshlrev_b32 v74, 16, v107
  v_and_b32 v75, s80, v107
  v_mul_f32 v72, s81, v72
  v_mul_f32 v73, s81, v73
  v_mul_f32 v74, s81, v74
  v_mul_f32 v75, s81, v75
  v_cvt_pk_bf16_f32 v106, v72, v73
  v_cvt_pk_bf16_f32 v107, v74, v75
  v_lshlrev_b32 v72, 16, v106
  v_and_b32 v73, s80, v106
  v_lshlrev_b32 v74, 16, v107
  v_and_b32 v75, s80, v107
  v_max3_f32 v14, v14, v72, v73
  v_max3_f32 v14, v14, v74, v75
  s_add_u32 s45, s44, 32768
  s_add_u32 m0, s46, 8192
  s_waitcnt vmcnt(4)
  buffer_load_dwordx4 v6, s[12:15], s45 offen offset:0 nt lds
  ds_read_b128 v[32:35], v8 offset:28672
  ds_read_b128 v[36:39], v9 offset:28672
  ds_read_b128 v[40:43], v10 offset:28672
  ds_read_b128 v[44:47], v11 offset:28672
  s_waitcnt lgkmcnt(3)
  v_mfma_f32_16x16x32_bf16 v[76:79], v[32:35], v[16:19], 0
  s_waitcnt lgkmcnt(2)
  v_mfma_f32_16x16x32_bf16 v[76:79], v[36:39], v[20:23], v[76:79]
  s_waitcnt lgkmcnt(1)
  v_mfma_f32_16x16x32_bf16 v[76:79], v[40:43], v[24:27], v[76:79]
  s_waitcnt lgkmcnt(0)
  v_mfma_f32_16x16x32_bf16 v[76:79], v[44:47], v[28:31], v[76:79]
  s_waitcnt vmcnt(4)
  buffer_load_dwordx4 v6, s[12:15], s45 offen offset:1024 nt lds
  s_nop 7
  v_cvt_pk_bf16_f32 v106, v76, v77
  v_cvt_pk_bf16_f32 v107, v78, v79
  v_lshlrev_b32 v76, 16, v106
  v_and_b32 v77, s80, v106
  v_lshlrev_b32 v78, 16, v107
  v_and_b32 v79, s80, v107
  v_mul_f32 v76, s81, v76
  v_mul_f32 v77, s81, v77
  v_mul_f32 v78, s81, v78
  v_mul_f32 v79, s81, v79
  v_cvt_pk_bf16_f32 v106, v76, v77
  v_cvt_pk_bf16_f32 v107, v78, v79
  v_lshlrev_b32 v76, 16, v106
  v_and_b32 v77, s80, v106
  v_lshlrev_b32 v78, 16, v107
  v_and_b32 v79, s80, v107
  v_max3_f32 v14, v14, v76, v77
  v_max3_f32 v14, v14, v78, v79
  v_mov_b32 v106, v14
  s_nop 1
  v_permlane16_swap_b32 v14, v106
  s_nop 1
  v_max_f32 v14, v14, v106
  v_mov_b32 v106, v14
  s_nop 1
  v_permlane32_swap_b32 v14, v106
  s_nop 1
  v_max_f32 v14, v14, v106
  v_sub_f32 v96, v90, v14
  v_mul_f32 v97, s48, v14
  v_mul_f32 v96, s48, v96
  v_mov_b32 v90, v14
  v_exp_f32 v96, v96
  s_nop 0
  v_mul_f32 v92, v92, v96
  v_mul_f32 v93, v93, v96
  v_mul_f32 v94, v94, v96
  v_mul_f32 v95, v95, v96
  v_mul_f32 v91, v91, v96
  s_waitcnt vmcnt(4)
  buffer_load_dwordx4 v6, s[12:15], s45 offen offset:2048 nt lds
  ds_read_b128 v[32:35], v12 offset:0
  ds_read_b128 v[36:39], v12 offset:256
  ds_read_b128 v[40:43], v12 offset:512
  ds_read_b128 v[44:47], v12 offset:768
  v_fma_f32 v48, v48, s48, -v97
  v_fma_f32 v49, v49, s48, -v97
  v_fma_f32 v50, v50, s48, -v97
  v_fma_f32 v51, v51, s48, -v97
  v_exp_f32 v48, v48
  v_exp_f32 v49, v49
  v_exp_f32 v50, v50
  v_exp_f32 v51, v51
  s_nop 0
  v_cvt_pk_bf16_f32 v80, v48, v49
  v_cvt_pk_bf16_f32 v81, v50, v51
  v_add_f32 v106, v48, v49
  v_add_f32 v107, v50, v51
  v_add_f32 v91, v91, v106
  v_add_f32 v91, v91, v107
  v_perm_b32 v82, v80, v80, v98
  v_perm_b32 v83, v80, v80, v99
  v_perm_b32 v84, v80, v80, v100
  v_perm_b32 v85, v80, v80, v101
  s_waitcnt lgkmcnt(3)
  s_nop 0
  v_mfma_f32_16x16x32_bf16 v[92:95], v[82:85], v[32:35], v[92:95]
  v_perm_b32 v86, v80, v80, v102
  v_perm_b32 v87, v80, v80, v103
  v_perm_b32 v88, v80, v80, v104
  v_perm_b32 v89, v80, v80, v105
  s_waitcnt lgkmcnt(2)
  s_nop 0
  v_mfma_f32_16x16x32_bf16 v[92:95], v[86:89], v[36:39], v[92:95]
  s_waitcnt vmcnt(4)
  buffer_load_dwordx4 v6, s[12:15], s45 offen offset:3072 nt lds
  v_perm_b32 v82, v81, v81, v98
  v_perm_b32 v83, v81, v81, v99
  v_perm_b32 v84, v81, v81, v100
  v_perm_b32 v85, v81, v81, v101
  s_waitcnt lgkmcnt(1)
  s_nop 0
  v_mfma_f32_16x16x32_bf16 v[92:95], v[82:85], v[40:43], v[92:95]
  v_perm_b32 v86, v81, v81, v102
  v_perm_b32 v87, v81, v81, v103
  v_perm_b32 v88, v81, v81, v104
  v_perm_b32 v89, v81, v81, v105
  s_waitcnt lgkmcnt(0)
  s_nop 0
  v_mfma_f32_16x16x32_bf16 v[92:95], v[86:89], v[44:47], v[92:95]
  s_add_u32 s45, s44, 36864
  s_add_u32 m0, s46, 12288
  s_waitcnt vmcnt(4)
  buffer_load_dwordx4 v6, s[12:15], s45 offen offset:0 nt lds
  ds_read_b128 v[32:35], v12 offset:4096
  ds_read_b128 v[36:39], v12 offset:4352
  ds_read_b128 v[40:43], v12 offset:4608
  ds_read_b128 v[44:47], v12 offset:4864
  v_fma_f32 v52, v52, s48, -v97
  v_fma_f32 v53, v53, s48, -v97
  v_fma_f32 v54, v54, s48, -v97
  v_fma_f32 v55, v55, s48, -v97
  v_exp_f32 v52, v52
  v_exp_f32 v53, v53
  v_exp_f32 v54, v54
  v_exp_f32 v55, v55
  s_nop 0
  v_cvt_pk_bf16_f32 v80, v52, v53
  v_cvt_pk_bf16_f32 v81, v54, v55
  v_add_f32 v106, v52, v53
  v_add_f32 v107, v54, v55
  v_add_f32 v91, v91, v106
  v_add_f32 v91, v91, v107
  v_perm_b32 v82, v80, v80, v98
  v_perm_b32 v83, v80, v80, v99
  v_perm_b32 v84, v80, v80, v100
  v_perm_b32 v85, v80, v80, v101
  s_waitcnt lgkmcnt(3)
  s_nop 0
  v_mfma_f32_16x16x32_bf16 v[92:95], v[82:85], v[32:35], v[92:95]
  s_waitcnt vmcnt(4)
  buffer_load_dwordx4 v6, s[12:15], s45 offen offset:1024 nt lds
  v_perm_b32 v86, v80, v80, v102
  v_perm_b32 v87, v80, v80, v103
  v_perm_b32 v88, v80, v80, v104
  v_perm_b32 v89, v80, v80, v105
  s_waitcnt lgkmcnt(2)
  s_nop 0
  v_mfma_f32_16x16x32_bf16 v[92:95], v[86:89], v[36:39], v[92:95]
  s_waitcnt vmcnt(4)
  buffer_load_dwordx4 v6, s[12:15], s45 offen offset:2048 nt lds
  v_perm_b32 v82, v81, v81, v98
  v_perm_b32 v83, v81, v81, v99
  v_perm_b32 v84, v81, v81, v100
  v_perm_b32 v85, v81, v81, v101
  s_waitcnt lgkmcnt(1)
  s_nop 0
  v_mfma_f32_16x16x32_bf16 v[92:95], v[82:85], v[40:43], v[92:95]
  s_waitcnt vmcnt(4)
  buffer_load_dwordx4 v6, s[12:15], s45 offen offset:3072 nt lds
  v_perm_b32 v86, v81, v81, v102
  v_perm_b32 v87, v81, v81, v103
  v_perm_b32 v88, v81, v81, v104
  v_perm_b32 v89, v81, v81, v105
  s_waitcnt lgkmcnt(0)
  s_nop 0
  v_mfma_f32_16x16x32_bf16 v[92:95], v[86:89], v[44:47], v[92:95]
  s_add_u32 s45, s44, 65536
  s_add_u32 m0, s46, 16384
  s_waitcnt vmcnt(4)
  buffer_load_dwordx4 v6, s[12:15], s45 offen offset:0 nt lds
  ds_read_b128 v[32:35], v12 offset:8192
  ds_read_b128 v[36:39], v12 offset:8448
  ds_read_b128 v[40:43], v12 offset:8704
  ds_read_b128 v[44:47], v12 offset:8960
  v_fma_f32 v56, v56, s48, -v97
  v_fma_f32 v57, v57, s48, -v97
  v_fma_f32 v58, v58, s48, -v97
  v_fma_f32 v59, v59, s48, -v97
  v_exp_f32 v56, v56
  v_exp_f32 v57, v57
  v_exp_f32 v58, v58
  v_exp_f32 v59, v59
  s_nop 0
  v_cvt_pk_bf16_f32 v80, v56, v57
  v_cvt_pk_bf16_f32 v81, v58, v59
  v_add_f32 v106, v56, v57
  v_add_f32 v107, v58, v59
  v_add_f32 v91, v91, v106
  v_add_f32 v91, v91, v107
  v_perm_b32 v82, v80, v80, v98
  v_perm_b32 v83, v80, v80, v99
  v_perm_b32 v84, v80, v80, v100
  v_perm_b32 v85, v80, v80, v101
  s_waitcnt lgkmcnt(3)
  s_nop 0
  v_mfma_f32_16x16x32_bf16 v[92:95], v[82:85], v[32:35], v[92:95]
  s_waitcnt vmcnt(4)
  buffer_load_dwordx4 v6, s[12:15], s45 offen offset:1024 nt lds
  v_perm_b32 v86, v80, v80, v102
  v_perm_b32 v87, v80, v80, v103
  v_perm_b32 v88, v80, v80, v104
  v_perm_b32 v89, v80, v80, v105
  s_waitcnt lgkmcnt(2)
  s_nop 0
  v_mfma_f32_16x16x32_bf16 v[92:95], v[86:89], v[36:39], v[92:95]
  s_waitcnt vmcnt(4)
  buffer_load_dwordx4 v6, s[12:15], s45 offen offset:2048 nt lds
  v_perm_b32 v82, v81, v81, v98
  v_perm_b32 v83, v81, v81, v99
  v_perm_b32 v84, v81, v81, v100
  v_perm_b32 v85, v81, v81, v101
  s_waitcnt lgkmcnt(1)
  s_nop 0
  v_mfma_f32_16x16x32_bf16 v[92:95], v[82:85], v[40:43], v[92:95]
  s_waitcnt vmcnt(4)
  buffer_load_dwordx4 v6, s[12:15], s45 offen offset:3072 nt lds
  v_perm_b32 v86, v81, v81, v102
  v_perm_b32 v87, v81, v81, v103
  v_perm_b32 v88, v81, v81, v104
  v_perm_b32 v89, v81, v81, v105
  s_waitcnt lgkmcnt(0)
  s_nop 0
  v_mfma_f32_16x16x32_bf16 v[92:95], v[86:89], v[44:47], v[92:95]
  s_add_u32 s45, s44, 69632
  s_add_u32 m0, s46, 20480
  s_waitcnt vmcnt(4)
  buffer_load_dwordx4 v6, s[12:15], s45 offen offset:0 nt lds
  ds_read_b128 v[32:35], v12 offset:12288
  ds_read_b128 v[36:39], v12 offset:12544
  ds_read_b128 v[40:43], v12 offset:12800
  ds_read_b128 v[44:47], v12 offset:13056
  v_fma_f32 v60, v60, s48, -v97
  v_fma_f32 v61, v61, s48, -v97
  v_fma_f32 v62, v62, s48, -v97
  v_fma_f32 v63, v63, s48, -v97
  v_exp_f32 v60, v60
  v_exp_f32 v61, v61
  v_exp_f32 v62, v62
  v_exp_f32 v63, v63
  s_nop 0
  v_cvt_pk_bf16_f32 v80, v60, v61
  v_cvt_pk_bf16_f32 v81, v62, v63
  v_add_f32 v106, v60, v61
  v_add_f32 v107, v62, v63
  v_add_f32 v91, v91, v106
  v_add_f32 v91, v91, v107
  v_perm_b32 v82, v80, v80, v98
  v_perm_b32 v83, v80, v80, v99
  v_perm_b32 v84, v80, v80, v100
  v_perm_b32 v85, v80, v80, v101
  s_waitcnt lgkmcnt(3)
  s_nop 0
  v_mfma_f32_16x16x32_bf16 v[92:95], v[82:85], v[32:35], v[92:95]
  s_waitcnt vmcnt(4)
  buffer_load_dwordx4 v6, s[12:15], s45 offen offset:1024 nt lds
  v_perm_b32 v86, v80, v80, v102
  v_perm_b32 v87, v80, v80, v103
  v_perm_b32 v88, v80, v80, v104
  v_perm_b32 v89, v80, v80, v105
  s_waitcnt lgkmcnt(2)
  s_nop 0
  v_mfma_f32_16x16x32_bf16 v[92:95], v[86:89], v[36:39], v[92:95]
  s_waitcnt vmcnt(4)
  buffer_load_dwordx4 v6, s[12:15], s45 offen offset:2048 nt lds
  v_perm_b32 v82, v81, v81, v98
  v_perm_b32 v83, v81, v81, v99
  v_perm_b32 v84, v81, v81, v100
  v_perm_b32 v85, v81, v81, v101
  s_waitcnt lgkmcnt(1)
  s_nop 0
  v_mfma_f32_16x16x32_bf16 v[92:95], v[82:85], v[40:43], v[92:95]
  s_waitcnt vmcnt(4)
  buffer_load_dwordx4 v6, s[12:15], s45 offen offset:3072 nt lds
  v_perm_b32 v86, v81, v81, v102
  v_perm_b32 v87, v81, v81, v103
  v_perm_b32 v88, v81, v81, v104
  v_perm_b32 v89, v81, v81, v105
  s_waitcnt lgkmcnt(0)
  s_nop 0
  v_mfma_f32_16x16x32_bf16 v[92:95], v[86:89], v[44:47], v[92:95]
  s_add_u32 s45, s44, 98304
  s_add_u32 m0, s46, 24576
  s_waitcnt vmcnt(4)
  buffer_load_dwordx4 v6, s[12:15], s45 offen offset:0 nt lds
  ds_read_b128 v[32:35], v12 offset:16384
  ds_read_b128 v[36:39], v12 offset:16640
  ds_read_b128 v[40:43], v12 offset:16896
  ds_read_b128 v[44:47], v12 offset:17152
  v_fma_f32 v64, v64, s48, -v97
  v_fma_f32 v65, v65, s48, -v97
  v_fma_f32 v66, v66, s48, -v97
  v_fma_f32 v67, v67, s48, -v97
  v_exp_f32 v64, v64
  v_exp_f32 v65, v65
  v_exp_f32 v66, v66
  v_exp_f32 v67, v67
  s_nop 0
  v_cvt_pk_bf16_f32 v80, v64, v65
  v_cvt_pk_bf16_f32 v81, v66, v67
  v_add_f32 v106, v64, v65
  v_add_f32 v107, v66, v67
  v_add_f32 v91, v91, v106
  v_add_f32 v91, v91, v107
  v_perm_b32 v82, v80, v80, v98
  v_perm_b32 v83, v80, v80, v99
  v_perm_b32 v84, v80, v80, v100
  v_perm_b32 v85, v80, v80, v101
  s_waitcnt lgkmcnt(3)
  s_nop 0
  v_mfma_f32_16x16x32_bf16 v[92:95], v[82:85], v[32:35], v[92:95]
  s_waitcnt vmcnt(4)
  buffer_load_dwordx4 v6, s[12:15], s45 offen offset:1024 nt lds
  v_perm_b32 v86, v80, v80, v102
  v_perm_b32 v87, v80, v80, v103
  v_perm_b32 v88, v80, v80, v104
  v_perm_b32 v89, v80, v80, v105
  s_waitcnt lgkmcnt(2)
  s_nop 0
  v_mfma_f32_16x16x32_bf16 v[92:95], v[86:89], v[36:39], v[92:95]
  s_waitcnt vmcnt(4)
  buffer_load_dwordx4 v6, s[12:15], s45 offen offset:2048 nt lds
  v_perm_b32 v82, v81, v81, v98
  v_perm_b32 v83, v81, v81, v99
  v_perm_b32 v84, v81, v81, v100
  v_perm_b32 v85, v81, v81, v101
  s_waitcnt lgkmcnt(1)
  s_nop 0
  v_mfma_f32_16x16x32_bf16 v[92:95], v[82:85], v[40:43], v[92:95]
  s_waitcnt vmcnt(4)
  buffer_load_dwordx4 v6, s[12:15], s45 offen offset:3072 nt lds
  v_perm_b32 v86, v81, v81, v102
  v_perm_b32 v87, v81, v81, v103
  v_perm_b32 v88, v81, v81, v104
  v_perm_b32 v89, v81, v81, v105
  s_waitcnt lgkmcnt(0)
  s_nop 0
  v_mfma_f32_16x16x32_bf16 v[92:95], v[86:89], v[44:47], v[92:95]
  s_add_u32 s45, s44, 102400
  s_add_u32 m0, s46, 28672
  s_waitcnt vmcnt(4)
  buffer_load_dwordx4 v6, s[12:15], s45 offen offset:0 nt lds
  ds_read_b128 v[32:35], v12 offset:20480
  ds_read_b128 v[36:39], v12 offset:20736
  ds_read_b128 v[40:43], v12 offset:20992
  ds_read_b128 v[44:47], v12 offset:21248
  v_fma_f32 v68, v68, s48, -v97
  v_fma_f32 v69, v69, s48, -v97
  v_fma_f32 v70, v70, s48, -v97
  v_fma_f32 v71, v71, s48, -v97
  v_exp_f32 v68, v68
  v_exp_f32 v69, v69
  v_exp_f32 v70, v70
  v_exp_f32 v71, v71
  s_nop 0
  v_cvt_pk_bf16_f32 v80, v68, v69
  v_cvt_pk_bf16_f32 v81, v70, v71
  v_add_f32 v106, v68, v69
  v_add_f32 v107, v70, v71
  v_add_f32 v91, v91, v106
  v_add_f32 v91, v91, v107
  v_perm_b32 v82, v80, v80, v98
  v_perm_b32 v83, v80, v80, v99
  v_perm_b32 v84, v80, v80, v100
  v_perm_b32 v85, v80, v80, v101
  s_waitcnt lgkmcnt(3)
  s_nop 0
  v_mfma_f32_16x16x32_bf16 v[92:95], v[82:85], v[32:35], v[92:95]
  s_waitcnt vmcnt(4)
  buffer_load_dwordx4 v6, s[12:15], s45 offen offset:1024 nt lds
  v_perm_b32 v86, v80, v80, v102
  v_perm_b32 v87, v80, v80, v103
  v_perm_b32 v88, v80, v80, v104
  v_perm_b32 v89, v80, v80, v105
  s_waitcnt lgkmcnt(2)
  s_nop 0
  v_mfma_f32_16x16x32_bf16 v[92:95], v[86:89], v[36:39], v[92:95]
  s_waitcnt vmcnt(4)
  buffer_load_dwordx4 v6, s[12:15], s45 offen offset:2048 nt lds
  v_perm_b32 v82, v81, v81, v98
  v_perm_b32 v83, v81, v81, v99
  v_perm_b32 v84, v81, v81, v100
  v_perm_b32 v85, v81, v81, v101
  s_waitcnt lgkmcnt(1)
  s_nop 0
  v_mfma_f32_16x16x32_bf16 v[92:95], v[82:85], v[40:43], v[92:95]
  s_waitcnt vmcnt(4)
  buffer_load_dwordx4 v6, s[12:15], s45 offen offset:3072 nt lds
  s_add_u32 s44, s44, 131072
  v_perm_b32 v86, v81, v81, v102
  v_perm_b32 v87, v81, v81, v103
  v_perm_b32 v88, v81, v81, v104
  v_perm_b32 v89, v81, v81, v105
  s_waitcnt lgkmcnt(0)
  s_nop 0
  v_mfma_f32_16x16x32_bf16 v[92:95], v[86:89], v[44:47], v[92:95]
  s_add_u32 s45, s44, 0
  s_add_u32 m0, s46, 0
  s_waitcnt vmcnt(4)
  buffer_load_dwordx4 v2, s[8:11], s45 offen offset:0 nt lds
  ds_read_b128 v[32:35], v12 offset:24576
  ds_read_b128 v[36:39], v12 offset:24832
  ds_read_b128 v[40:43], v12 offset:25088
  ds_read_b128 v[44:47], v12 offset:25344
  v_fma_f32 v72, v72, s48, -v97
  v_fma_f32 v73, v73, s48, -v97
  v_fma_f32 v74, v74, s48, -v97
  v_fma_f32 v75, v75, s48, -v97
  v_exp_f32 v72, v72
  v_exp_f32 v73, v73
  v_exp_f32 v74, v74
  v_exp_f32 v75, v75
  s_nop 0
  v_cvt_pk_bf16_f32 v80, v72, v73
  v_cvt_pk_bf16_f32 v81, v74, v75
  v_add_f32 v106, v72, v73
  v_add_f32 v107, v74, v75
  v_add_f32 v91, v91, v106
  v_add_f32 v91, v91, v107
  v_perm_b32 v82, v80, v80, v98
  v_perm_b32 v83, v80, v80, v99
  v_perm_b32 v84, v80, v80, v100
  v_perm_b32 v85, v80, v80, v101
  s_waitcnt lgkmcnt(3)
  s_nop 0
  v_mfma_f32_16x16x32_bf16 v[92:95], v[82:85], v[32:35], v[92:95]
  s_waitcnt vmcnt(4)
  buffer_load_dwordx4 v3, s[8:11], s45 offen offset:1024 nt lds
  v_perm_b32 v86, v80, v80, v102
  v_perm_b32 v87, v80, v80, v103
  v_perm_b32 v88, v80, v80, v104
  v_perm_b32 v89, v80, v80, v105
  s_waitcnt lgkmcnt(2)
  s_nop 0
  v_mfma_f32_16x16x32_bf16 v[92:95], v[86:89], v[36:39], v[92:95]
  s_waitcnt vmcnt(4)
  buffer_load_dwordx4 v4, s[8:11], s45 offen offset:2048 nt lds
  v_perm_b32 v82, v81, v81, v98
  v_perm_b32 v83, v81, v81, v99
  v_perm_b32 v84, v81, v81, v100
  v_perm_b32 v85, v81, v81, v101
  s_waitcnt lgkmcnt(1)
  s_nop 0
  v_mfma_f32_16x16x32_bf16 v[92:95], v[82:85], v[40:43], v[92:95]
  s_waitcnt vmcnt(4)
  buffer_load_dwordx4 v5, s[8:11], s45 offen offset:3072 nt lds
  v_perm_b32 v86, v81, v81, v102
  v_perm_b32 v87, v81, v81, v103
  v_perm_b32 v88, v81, v81, v104
  v_perm_b32 v89, v81, v81, v105
  s_waitcnt lgkmcnt(0)
  s_nop 0
  v_mfma_f32_16x16x32_bf16 v[92:95], v[86:89], v[44:47], v[92:95]
  s_add_u32 s45, s44, 4096
  s_add_u32 m0, s46, 4096
  s_waitcnt vmcnt(4)
  buffer_load_dwordx4 v2, s[8:11], s45 offen offset:0 nt lds
  ds_read_b128 v[32:35], v12 offset:28672
  ds_read_b128 v[36:39], v12 offset:28928
  ds_read_b128 v[40:43], v12 offset:29184
  ds_read_b128 v[44:47], v12 offset:29440
  v_fma_f32 v76, v76, s48, -v97
  v_fma_f32 v77, v77, s48, -v97
  v_fma_f32 v78, v78, s48, -v97
  v_fma_f32 v79, v79, s48, -v97
  v_exp_f32 v76, v76
  v_exp_f32 v77, v77
  v_exp_f32 v78, v78
  v_exp_f32 v79, v79
  s_nop 0
  v_cvt_pk_bf16_f32 v80, v76, v77
  v_cvt_pk_bf16_f32 v81, v78, v79
  v_add_f32 v106, v76, v77
  v_add_f32 v107, v78, v79
  v_add_f32 v91, v91, v106
  v_add_f32 v91, v91, v107
  v_perm_b32 v82, v80, v80, v98
  v_perm_b32 v83, v80, v80, v99
  v_perm_b32 v84, v80, v80, v100
  v_perm_b32 v85, v80, v80, v101
  s_waitcnt lgkmcnt(3)
  s_nop 0
  v_mfma_f32_16x16x32_bf16 v[92:95], v[82:85], v[32:35], v[92:95]
  s_waitcnt vmcnt(4)
  buffer_load_dwordx4 v3, s[8:11], s45 offen offset:1024 nt lds
  v_perm_b32 v86, v80, v80, v102
  v_perm_b32 v87, v80, v80, v103
  v_perm_b32 v88, v80, v80, v104
  v_perm_b32 v89, v80, v80, v105
  s_waitcnt lgkmcnt(2)
  s_nop 0
  v_mfma_f32_16x16x32_bf16 v[92:95], v[86:89], v[36:39], v[92:95]
  s_waitcnt vmcnt(4)
  buffer_load_dwordx4 v4, s[8:11], s45 offen offset:2048 nt lds
  v_perm_b32 v82, v81, v81, v98
  v_perm_b32 v83, v81, v81, v99
  v_perm_b32 v84, v81, v81, v100
  v_perm_b32 v85, v81, v81, v101
  s_waitcnt lgkmcnt(1)
  s_nop 0
  v_mfma_f32_16x16x32_bf16 v[92:95], v[82:85], v[40:43], v[92:95]
  s_waitcnt vmcnt(4)
  buffer_load_dwordx4 v5, s[8:11], s45 offen offset:3072 nt lds
  v_perm_b32 v86, v81, v81, v102
  v_perm_b32 v87, v81, v81, v103
  v_perm_b32 v88, v81, v81, v104
  v_perm_b32 v89, v81, v81, v105
  s_waitcnt lgkmcnt(0)
  s_nop 0
  v_mfma_f32_16x16x32_bf16 v[92:95], v[86:89], v[44:47], v[92:95]
  s_add_u32 s45, s44, 32768
  s_add_u32 m0, s46, 8192
  s_waitcnt vmcnt(4)
  buffer_load_dwordx4 v2, s[8:11], s45 offen offset:0 nt lds
  s_waitcnt vmcnt(4)
  buffer_load_dwordx4 v3, s[8:11], s45 offen offset:1024 nt lds
  s_mul_i32 s40, s38, 73728
  s_add_u32 s52, s36, s40
  s_addc_u32 s53, s37, 0
  s_mov_b32 s54, 73728
  s_mov_b32 s55, 0x20000
  s_mul_i32 s42, s3, 36
  v_and_b32 v210, 31, v0
  v_add_u32 v210, s42, v210
  v_lshlrev_b32 v204, 4, v210
  v_lshrrev_b32 v211, 5, v0
  s_mov_b32 s43, 36864
  v_mul_lo_u32 v211, v211, s43
  v_add_u32 v204, v204, v211
  v_mov_b32 v212, 0x7f000000
  v_cmp_gt_u32 vcc, 32, v0
  s_nop 1
  v_mov_b32 v205, v204
  v_and_b32 v210, 3, v0
  v_add_u32 v210, s42, v210
  v_add_u32 v210, 32, v210
  v_lshlrev_b32 v206, 4, v210
  v_lshrrev_b32 v211, 2, v0
  s_movk_i32 s43, 4608
  v_mul_lo_u32 v211, v211, s43
  v_add_u32 v206, v206, v211
  v_add_u32 v207, 2304, v206
  v_cmp_gt_u32 vcc, 4, v0
  s_nop 1
  v_add_u32 v210, s42, v0
  v_lshlrev_b32 v208, 4, v210
  v_add_u32 v208, 140352, v208
  v_lshlrev_b32 v209, 3, v210
  v_cmp_gt_u32 vcc, 36, v0
  s_nop 1
  v_cndmask_b32 v209, v212, v209, vcc
  s_mul_i32 s40, s38, 1152
  s_add_u32 s56, s16, s40
  s_addc_u32 s57, s17, 0
  s_mov_b32 s58, 1152
  s_mov_b32 s59, 0x20000
  buffer_load_dwordx2 v[200:201], v209, s[56:59], 0 offen
  s_mov_b32 s56, s30
  s_mov_b32 s57, s31
  s_mov_b32 s58, 1152
  s_mov_b32 s59, 0x20000
  buffer_load_dwordx2 v[202:203], v209, s[56:59], 0 offen
  s_mov_b32 s82, 5
  s_mov_b32 s47, 1
L_sloop:
  s_cmp_gt_u32 s47, 5
  s_cselect_b32 s82, 7, s82
  s_cmp_eq_u32 s82, 5
  s_cbranch_scc1 L_ver5
L_ver7:
  s_add_u32 s45, s44, 32768
  s_add_u32 m0, s46, 8192
  s_waitcnt vmcnt(6)
  buffer_load_dwordx4 v4, s[8:11], s45 offen offset:2048 nt lds
  ds_read_b128 v[32:35], v8 offset:0
  ds_read_b128 v[36:39], v9 offset:0
  ds_read_b128 v[40:43], v10 offset:0
  ds_read_b128 v[44:47], v11 offset:0
  s_waitcnt vmcnt(6)
  buffer_load_dwordx4 v5, s[8:11], s45 offen offset:3072 nt lds
  s_waitcnt lgkmcnt(3)
  v_mfma_f32_16x16x32_bf16 v[48:51], v[32:35], v[16:19], 0
  s_waitcnt lgkmcnt(2)
  v_mfma_f32_16x16x32_bf16 v[48:51], v[36:39], v[20:23], v[48:51]
  s_waitcnt lgkmcnt(1)
  v_mfma_f32_16x16x32_bf16 v[48:51], v[40:43], v[24:27], v[48:51]
  s_waitcnt lgkmcnt(0)
  v_mfma_f32_16x16x32_bf16 v[48:51], v[44:47], v[28:31], v[48:51]
  s_add_u32 s45, s44, 36864
  s_add_u32 m0, s46, 12288
  s_waitcnt vmcnt(6)
  buffer_load_dwordx4 v2, s[8:11], s45 offen offset:0 nt lds
  s_nop 7
  v_cvt_pk_bf16_f32 v106, v48, v49
  v_cvt_pk_bf16_f32 v107, v50, v51
  v_lshlrev_b32 v48, 16, v106
  v_and_b32 v49, s80, v106
  v_lshlrev_b32 v50, 16, v107
  v_and_b32 v51, s80, v107
  v_mul_f32 v48, s81, v48
  v_mul_f32 v49, s81, v49
  v_mul_f32 v50, s81, v50
  v_mul_f32 v51, s81, v51
  v_cvt_pk_bf16_f32 v106, v48, v49
  v_cvt_pk_bf16_f32 v107, v50, v51
  v_lshlrev_b32 v48, 16, v106
  v_and_b32 v49, s80, v106
  v_lshlrev_b32 v50, 16, v107
  v_and_b32 v51, s80, v107
  v_max3_f32 v14, v90, v48, v49
  v_max3_f32 v14, v14, v50, v51
  s_waitcnt vmcnt(6)
  buffer_load_dwordx4 v3, s[8:11], s45 offen offset:1024 nt lds
  s_waitcnt vmcnt(6)
  buffer_load_dwordx4 v4, s[8:11], s45 offen offset:2048 nt lds
  ds_read_b128 v[32:35], v8 offset:4096
  ds_read_b128 v[36:39], v9 offset:4096
  ds_read_b128 v[40:43], v10 offset:4096
  ds_read_b128 v[44:47], v11 offset:4096
  s_waitcnt vmcnt(6)
  buffer_load_dwordx4 v5, s[8:11], s45 offen offset:3072 nt lds
  s_waitcnt lgkmcnt(3)
  v_mfma_f32_16x16x32_bf16 v[52:55], v[32:35], v[16:19], 0
  s_waitcnt lgkmcnt(2)
  v_mfma_f32_16x16x32_bf16 v[52:55], v[36:39], v[20:23], v[52:55]
  s_waitcnt lgkmcnt(1)
  v_mfma_f32_16x16x32_bf16 v[52:55], v[40:43], v[24:27], v[52:55]
  s_waitcnt lgkmcnt(0)
  v_mfma_f32_16x16x32_bf16 v[52:55], v[44:47], v[28:31], v[52:55]
  s_add_u32 s45, s44, 65536
  s_add_u32 m0, s46, 16384
  s_waitcnt vmcnt(6)
  buffer_load_dwordx4 v2, s[8:11], s45 offen offset:0 nt lds
  s_nop 7
  v_cvt_pk_bf16_f32 v106, v52, v53
  v_cvt_pk_bf16_f32 v107, v54, v55
  v_lshlrev_b32 v52, 16, v106
  v_and_b32 v53, s80, v106
  v_lshlrev_b32 v54, 16, v107
  v_and_b32 v55, s80, v107
  v_mul_f32 v52, s81, v52
  v_mul_f32 v53, s81, v53
  v_mul_f32 v54, s81, v54
  v_mul_f32 v55, s81, v55
  v_cvt_pk_bf16_f32 v106, v52, v53
  v_cvt_pk_bf16_f32 v107, v54, v55
  v_lshlrev_b32 v52, 16, v106
  v_and_b32 v53, s80, v106
  v_lshlrev_b32 v54, 16, v107
  v_and_b32 v55, s80, v107
  v_max3_f32 v14, v14, v52, v53
  v_max3_f32 v14, v14, v54, v55
  s_waitcnt vmcnt(6)
  buffer_load_dwordx4 v3, s[8:11], s45 offen offset:1024 nt lds
  s_waitcnt vmcnt(6)
  buffer_load_dwordx4 v4, s[8:11], s45 offen offset:2048 nt lds
  ds_read_b128 v[32:35], v8 offset:8192
  ds_read_b128 v[36:39], v9 offset:8192
  ds_read_b128 v[40:43], v10 offset:8192
  ds_read_b128 v[44:47], v11 offset:8192
  s_waitcnt vmcnt(6)
  buffer_load_dwordx4 v5, s[8:11], s45 offen offset:3072 nt lds
  s_waitcnt lgkmcnt(3)
  v_mfma_f32_16x16x32_bf16 v[56:59], v[32:35], v[16:19], 0
  s_waitcnt lgkmcnt(2)
  v_mfma_f32_16x16x32_bf16 v[56:59], v[36:39], v[20:23], v[56:59]
  s_waitcnt lgkmcnt(1)
  v_mfma_f32_16x16x32_bf16 v[56:59], v[40:43], v[24:27], v[56:59]
  s_waitcnt lgkmcnt(0)
  v_mfma_f32_16x16x32_bf16 v[56:59], v[44:47], v[28:31], v[56:59]
  s_add_u32 s45, s44, 69632
  s_add_u32 m0, s46, 20480
  s_waitcnt vmcnt(6)
  buffer_load_dwordx4 v2, s[8:11], s45 offen offset:0 nt lds
  s_nop 7
  v_cvt_pk_bf16_f32 v106, v56, v57
  v_cvt_pk_bf16_f32 v107, v58, v59
  v_lshlrev_b32 v56, 16, v106
  v_and_b32 v57, s80, v106
  v_lshlrev_b32 v58, 16, v107
  v_and_b32 v59, s80, v107
  v_mul_f32 v56, s81, v56
  v_mul_f32 v57, s81, v57
  v_mul_f32 v58, s81, v58
  v_mul_f32 v59, s81, v59
  v_cvt_pk_bf16_f32 v106, v56, v57
  v_cvt_pk_bf16_f32 v107, v58, v59
  v_lshlrev_b32 v56, 16, v106
  v_and_b32 v57, s80, v106
  v_lshlrev_b32 v58, 16, v107
  v_and_b32 v59, s80, v107
  v_max3_f32 v14, v14, v56, v57
  v_max3_f32 v14, v14, v58, v59
  s_waitcnt vmcnt(6)
  buffer_load_dwordx4 v3, s[8:11], s45 offen offset:1024 nt lds
  s_waitcnt vmcnt(6)
  buffer_load_dwordx4 v4, s[8:11], s45 offen offset:2048 nt lds
  ds_read_b128 v[32:35], v8 offset:12288
  ds_read_b128 v[36:39], v9 offset:12288
  ds_read_b128 v[40:43], v10 offset:12288
  ds_read_b128 v[44:47], v11 offset:12288
  s_waitcnt vmcnt(6)
  buffer_load_dwordx4 v5, s[8:11], s45 offen offset:3072 nt lds
  s_waitcnt lgkmcnt(3)
  v_mfma_f32_16x16x32_bf16 v[60:63], v[32:35], v[16:19], 0
  s_waitcnt lgkmcnt(2)
  v_mfma_f32_16x16x32_bf16 v[60:63], v[36:39], v[20:23], v[60:63]
  s_waitcnt lgkmcnt(1)
  v_mfma_f32_16x16x32_bf16 v[60:63], v[40:43], v[24:27], v[60:63]
  s_waitcnt lgkmcnt(0)
  v_mfma_f32_16x16x32_bf16 v[60:63], v[44:47], v[28:31], v[60:63]
  s_add_u32 s45, s44, 98304
  s_add_u32 m0, s46, 24576
  s_waitcnt vmcnt(6)
  buffer_load_dwordx4 v2, s[8:11], s45 offen offset:0 nt lds
  s_nop 7
  v_cvt_pk_bf16_f32 v106, v60, v61
  v_cvt_pk_bf16_f32 v107, v62, v63
  v_lshlrev_b32 v60, 16, v106
  v_and_b32 v61, s80, v106
  v_lshlrev_b32 v62, 16, v107
  v_and_b32 v63, s80, v107
  v_mul_f32 v60, s81, v60
  v_mul_f32 v61, s81, v61
  v_mul_f32 v62, s81, v62
  v_mul_f32 v63, s81, v63
  v_cvt_pk_bf16_f32 v106, v60, v61
  v_cvt_pk_bf16_f32 v107, v62, v63
  v_lshlrev_b32 v60, 16, v106
  v_and_b32 v61, s80, v106
  v_lshlrev_b32 v62, 16, v107
  v_and_b32 v63, s80, v107
  v_max3_f32 v14, v14, v60, v61
  v_max3_f32 v14, v14, v62, v63
  s_waitcnt vmcnt(6)
  buffer_load_dwordx4 v3, s[8:11], s45 offen offset:1024 nt lds
  s_waitcnt vmcnt(6)
  buffer_load_dwordx4 v4, s[8:11], s45 offen offset:2048 nt lds
  ds_read_b128 v[32:35], v8 offset:16384
  ds_read_b128 v[36:39], v9 offset:16384
  ds_read_b128 v[40:43], v10 offset:16384
  ds_read_b128 v[44:47], v11 offset:16384
  s_waitcnt vmcnt(6)
  buffer_load_dwordx4 v5, s[8:11], s45 offen offset:3072 nt lds
  s_waitcnt lgkmcnt(3)
  v_mfma_f32_16x16x32_bf16 v[64:67], v[32:35], v[16:19], 0
  s_waitcnt lgkmcnt(2)
  v_mfma_f32_16x16x32_bf16 v[64:67], v[36:39], v[20:23], v[64:67]
  s_waitcnt lgkmcnt(1)
  v_mfma_f32_16x16x32_bf16 v[64:67], v[40:43], v[24:27], v[64:67]
  s_waitcnt lgkmcnt(0)
  v_mfma_f32_16x16x32_bf16 v[64:67], v[44:47], v[28:31], v[64:67]
  s_add_u32 s45, s44, 102400
  s_add_u32 m0, s46, 28672
  s_waitcnt vmcnt(6)
  buffer_load_dwordx4 v2, s[8:11], s45 offen offset:0 nt lds
  s_nop 7
  v_cvt_pk_bf16_f32 v106, v64, v65
  v_cvt_pk_bf16_f32 v107, v66, v67
  v_lshlrev_b32 v64, 16, v106
  v_and_b32 v65, s80, v106
  v_lshlrev_b32 v66, 16, v107
  v_and_b32 v67, s80, v107
  v_mul_f32 v64, s81, v64
  v_mul_f32 v65, s81, v65
  v_mul_f32 v66, s81, v66
  v_mul_f32 v67, s81, v67
  v_cvt_pk_bf16_f32 v106, v64, v65
  v_cvt_pk_bf16_f32 v107, v66, v67
  v_lshlrev_b32 v64, 16, v106
  v_and_b32 v65, s80, v106
  v_lshlrev_b32 v66, 16, v107
  v_and_b32 v67, s80, v107
  v_max3_f32 v14, v14, v64, v65
  v_max3_f32 v14, v14, v66, v67
  s_waitcnt vmcnt(6)
  buffer_load_dwordx4 v3, s[8:11], s45 offen offset:1024 nt lds
  s_waitcnt vmcnt(6)
  buffer_load_dwordx4 v4, s[8:11], s45 offen offset:2048 nt lds
  ds_read_b128 v[32:35], v8 offset:20480
  ds_read_b128 v[36:39], v9 offset:20480
  ds_read_b128 v[40:43], v10 offset:20480
  ds_read_b128 v[44:47], v11 offset:20480
  s_waitcnt vmcnt(6)
  buffer_load_dwordx4 v5, s[8:11], s45 offen offset:3072 nt lds
  s_waitcnt lgkmcnt(3)
  v_mfma_f32_16x16x32_bf16 v[68:71], v[32:35], v[16:19], 0
  s_waitcnt lgkmcnt(2)
  v_mfma_f32_16x16x32_bf16 v[68:71], v[36:39], v[20:23], v[68:71]
  s_waitcnt lgkmcnt(1)
  v_mfma_f32_16x16x32_bf16 v[68:71], v[40:43], v[24:27], v[68:71]
  s_waitcnt lgkmcnt(0)
  v_mfma_f32_16x16x32_bf16 v[68:71], v[44:47], v[28:31], v[68:71]
  s_add_u32 s45, s44, 0
  s_add_u32 m0, s46, 0
  s_waitcnt vmcnt(6)
  buffer_load_dwordx4 v6, s[12:15], s45 offen offset:0 nt lds
  s_nop 7
  v_cvt_pk_bf16_f32 v106, v68, v69
  v_cvt_pk_bf16_f32 v107, v70, v71
  v_lshlrev_b32 v68, 16, v106
  v_and_b32 v69, s80, v106
  v_lshlrev_b32 v70, 16, v107
  v_and_b32 v71, s80, v107
  v_mul_f32 v68, s81, v68
  v_mul_f32 v69, s81, v69
  v_mul_f32 v70, s81, v70
  v_mul_f32 v71, s81, v71
  v_cvt_pk_bf16_f32 v106, v68, v69
  v_cvt_pk_bf16_f32 v107, v70, v71
  v_lshlrev_b32 v68, 16, v106
  v_and_b32 v69, s80, v106
  v_lshlrev_b32 v70, 16, v107
  v_and_b32 v71, s80, v107
  v_max3_f32 v14, v14, v68, v69
  v_max3_f32 v14, v14, v70, v71
  s_waitcnt vmcnt(6)
  buffer_load_dwordx4 v6, s[12:15], s45 offen offset:1024 nt lds
  s_waitcnt vmcnt(6)
  buffer_load_dwordx4 v6, s[12:15], s45 offen offset:2048 nt lds
  ds_read_b128 v[32:35], v8 offset:24576
  ds_read_b128 v[36:39], v9 offset:24576
  ds_read_b128 v[40:43], v10 offset:24576
  ds_read_b128 v[44:47], v11 offset:24576
  s_waitcnt vmcnt(6)
  buffer_load_dwordx4 v6, s[12:15], s45 offen offset:3072 nt lds
  s_waitcnt lgkmcnt(3)
  v_mfma_f32_16x16x32_bf16 v[72:75], v[32:35], v[16:19], 0
  s_waitcnt lgkmcnt(2)
  v_mfma_f32_16x16x32_bf16 v[72:75], v[36:39], v[20:23], v[72:75]
  s_waitcnt lgkmcnt(1)
  v_mfma_f32_16x16x32_bf16 v[72:75], v[40:43], v[24:27], v[72:75]
  s_waitcnt lgkmcnt(0)
  v_mfma_f32_16x16x32_bf16 v[72:75], v[44:47], v[28:31], v[72:75]
  s_add_u32 s45, s44, 4096
  s_add_u32 m0, s46, 4096
  s_waitcnt vmcnt(6)
  buffer_load_dwordx4 v6, s[12:15], s45 offen offset:0 nt lds
  s_nop 7
  v_cvt_pk_bf16_f32 v106, v72, v73
  v_cvt_pk_bf16_f32 v107, v74, v75
  v_lshlrev_b32 v72, 16, v106
  v_and_b32 v73, s80, v106
  v_lshlrev_b32 v74, 16, v107
  v_and_b32 v75, s80, v107
  v_mul_f32 v72, s81, v72
  v_mul_f32 v73, s81, v73
  v_mul_f32 v74, s81, v74
  v_mul_f32 v75, s81, v75
  v_cvt_pk_bf16_f32 v106, v72, v73
  v_cvt_pk_bf16_f32 v107, v74, v75
  v_lshlrev_b32 v72, 16, v106
  v_and_b32 v73, s80, v106
  v_lshlrev_b32 v74, 16, v107
  v_and_b32 v75, s80, v107
  v_max3_f32 v14, v14, v72, v73
  v_max3_f32 v14, v14, v74, v75
  s_waitcnt vmcnt(6)
  buffer_load_dwordx4 v6, s[12:15], s45 offen offset:1024 nt lds
  s_waitcnt vmcnt(6)
  buffer_load_dwordx4 v6, s[12:15], s45 offen offset:2048 nt lds
  ds_read_b128 v[32:35], v8 offset:28672
  ds_read_b128 v[36:39], v9 offset:28672
  ds_read_b128 v[40:43], v10 offset:28672
  ds_read_b128 v[44:47], v11 offset:28672
  s_waitcnt vmcnt(6)
  buffer_load_dwordx4 v6, s[12:15], s45 offen offset:3072 nt lds
  s_waitcnt lgkmcnt(3)
  v_mfma_f32_16x16x32_bf16 v[76:79], v[32:35], v[16:19], 0
  s_waitcnt lgkmcnt(2)
  v_mfma_f32_16x16x32_bf16 v[76:79], v[36:39], v[20:23], v[76:79]
  s_waitcnt lgkmcnt(1)
  v_mfma_f32_16x16x32_bf16 v[76:79], v[40:43], v[24:27], v[76:79]
  s_waitcnt lgkmcnt(0)
  v_mfma_f32_16x16x32_bf16 v[76:79], v[44:47], v[28:31], v[76:79]
  s_add_u32 s45, s44, 32768
  s_add_u32 m0, s46, 8192
  s_waitcnt vmcnt(6)
  buffer_load_dwordx4 v6, s[12:15], s45 offen offset:0 nt lds
  s_nop 7
  v_cvt_pk_bf16_f32 v106, v76, v77
  v_cvt_pk_bf16_f32 v107, v78, v79
  v_lshlrev_b32 v76, 16, v106
  v_and_b32 v77, s80, v106
  v_lshlrev_b32 v78, 16, v107
  v_and_b32 v79, s80, v107
  v_mul_f32 v76, s81, v76
  v_mul_f32 v77, s81, v77
  v_mul_f32 v78, s81, v78
  v_mul_f32 v79, s81, v79
  v_cvt_pk_bf16_f32 v106, v76, v77
  v_cvt_pk_bf16_f32 v107, v78, v79
  v_lshlrev_b32 v76, 16, v106
  v_and_b32 v77, s80, v106
  v_lshlrev_b32 v78, 16, v107
  v_and_b32 v79, s80, v107
  v_max3_f32 v14, v14, v76, v77
  v_max3_f32 v14, v14, v78, v79
  s_waitcnt vmcnt(6)
  buffer_load_dwordx4 v6, s[12:15], s45 offen offset:1024 nt lds
  v_mov_b32 v106, v14
  s_nop 1
  v_permlane16_swap_b32 v14, v106
  s_nop 1
  v_max_f32 v14, v14, v106
  v_mov_b32 v106, v14
  s_nop 1
  v_permlane32_swap_b32 v14, v106
  s_nop 1
  v_max_f32 v14, v14, v106
  v_sub_f32 v96, v90, v14
  v_mul_f32 v97, s48, v14
  v_mul_f32 v96, s48, v96
  v_mov_b32 v90, v14
  v_exp_f32 v96, v96
  s_nop 0
  v_mul_f32 v92, v92, v96
  v_mul_f32 v93, v93, v96
  v_mul_f32 v94, v94, v96
  v_mul_f32 v95, v95, v96
  v_mul_f32 v91, v91, v96
  s_waitcnt vmcnt(6)
  buffer_load_dwordx4 v6, s[12:15], s45 offen offset:2048 nt lds
  ds_read_b128 v[32:35], v12 offset:0
  ds_read_b128 v[36:39], v12 offset:256
  ds_read_b128 v[40:43], v12 offset:512
  ds_read_b128 v[44:47], v12 offset:768
  v_fma_f32 v48, v48, s48, -v97
  v_fma_f32 v49, v49, s48, -v97
  v_fma_f32 v50, v50, s48, -v97
  v_fma_f32 v51, v51, s48, -v97
  v_exp_f32 v48, v48
  v_exp_f32 v49, v49
  v_exp_f32 v50, v50
  v_exp_f32 v51, v51
  s_nop 0
  v_cvt_pk_bf16_f32 v80, v48, v49
  v_cvt_pk_bf16_f32 v81, v50, v51
  v_add_f32 v106, v48, v49
  v_add_f32 v107, v50, v51
  v_add_f32 v91, v91, v106
  v_add_f32 v91, v91, v107
  v_perm_b32 v82, v80, v80, v98
  v_perm_b32 v83, v80, v80, v99
  v_perm_b32 v84, v80, v80, v100
  v_perm_b32 v85, v80, v80, v101
  s_waitcnt lgkmcnt(3)
  s_nop 0
  v_mfma_f32_16x16x32_bf16 v[92:95], v[82:85], v[32:35], v[92:95]
  s_waitcnt vmcnt(6)
  buffer_load_dwordx4 v6, s[12:15], s45 offen offset:3072 nt lds
  v_perm_b32 v86, v80, v80, v102
  v_perm_b32 v87, v80, v80, v103
  v_perm_b32 v88, v80, v80, v104
  v_perm_b32 v89, v80, v80, v105
  s_waitcnt lgkmcnt(2)
  s_nop 0
  v_mfma_f32_16x16x32_bf16 v[92:95], v[86:89], v[36:39], v[92:95]
  s_add_u32 s45, s44, 36864
  s_add_u32 m0, s46, 12288
  s_waitcnt vmcnt(6)
  buffer_load_dwordx4 v6, s[12:15], s45 offen offset:0 nt lds
  v_perm_b32 v82, v81, v81, v98
  v_perm_b32 v83, v81, v81, v99
  v_perm_b32 v84, v81, v81, v100
  v_perm_b32 v85, v81, v81, v101
  s_waitcnt lgkmcnt(1)
  s_nop 0
  v_mfma_f32_16x16x32_bf16 v[92:95], v[82:85], v[40:43], v[92:95]
  s_waitcnt vmcnt(6)
  buffer_load_dwordx4 v6, s[12:15], s45 offen offset:1024 nt lds
  v_perm_b32 v86, v81, v81, v102
  v_perm_b32 v87, v81, v81, v103
  v_perm_b32 v88, v81, v81, v104
  v_perm_b32 v89, v81, v81, v105
  s_waitcnt lgkmcnt(0)
  s_nop 0
  v_mfma_f32_16x16x32_bf16 v[92:95], v[86:89], v[44:47], v[92:95]
  s_waitcnt vmcnt(6)
  buffer_load_dwordx4 v6, s[12:15], s45 offen offset:2048 nt lds
  ds_read_b128 v[32:35], v12 offset:4096
  ds_read_b128 v[36:39], v12 offset:4352
  ds_read_b128 v[40:43], v12 offset:4608
  ds_read_b128 v[44:47], v12 offset:4864
  v_fma_f32 v52, v52, s48, -v97
  v_fma_f32 v53, v53, s48, -v97
  v_fma_f32 v54, v54, s48, -v97
  v_fma_f32 v55, v55, s48, -v97
  v_exp_f32 v52, v52
  v_exp_f32 v53, v53
  v_exp_f32 v54, v54
  v_exp_f32 v55, v55
  s_nop 0
  v_cvt_pk_bf16_f32 v80, v52, v53
  v_cvt_pk_bf16_f32 v81, v54, v55
  v_add_f32 v106, v52, v53
  v_add_f32 v107, v54, v55
  v_add_f32 v91, v91, v106
  v_add_f32 v91, v91, v107
  v_perm_b32 v82, v80, v80, v98
  v_perm_b32 v83, v80, v80, v99
  v_perm_b32 v84, v80, v80, v100
  v_perm_b32 v85, v80, v80, v101
  s_waitcnt lgkmcnt(3)
  s_nop 0
  v_mfma_f32_16x16x32_bf16 v[92:95], v[82:85], v[32:35], v[92:95]
  s_waitcnt vmcnt(6)
  buffer_load_dwordx4 v6, s[12:15], s45 offen offset:3072 nt lds
  v_perm_b32 v86, v80, v80, v102
  v_perm_b32 v87, v80, v80, v103
  v_perm_b32 v88, v80, v80, v104
  v_perm_b32 v89, v80, v80, v105
  s_waitcnt lgkmcnt(2)
  s_nop 0
  v_mfma_f32_16x16x32_bf16 v[92:95], v[86:89], v[36:39], v[92:95]
  s_add_u32 s45, s44, 65536
  s_add_u32 m0, s46, 16384
  s_waitcnt vmcnt(6)
  buffer_load_dwordx4 v6, s[12:15], s45 offen offset:0 nt lds
  v_perm_b32 v82, v81, v81, v98
  v_perm_b32 v83, v81, v81, v99
  v_perm_b32 v84, v81, v81, v100
  v_perm_b32 v85, v81, v81, v101
  s_waitcnt lgkmcnt(1)
  s_nop 0
  v_mfma_f32_16x16x32_bf16 v[92:95], v[82:85], v[40:43], v[92:95]
  s_waitcnt vmcnt(6)
  buffer_load_dwordx4 v6, s[12:15], s45 offen offset:1024 nt lds
  v_perm_b32 v86, v81, v81, v102
  v_perm_b32 v87, v81, v81, v103
  v_perm_b32 v88, v81, v81, v104
  v_perm_b32 v89, v81, v81, v105
  s_waitcnt lgkmcnt(0)
  s_nop 0
  v_mfma_f32_16x16x32_bf16 v[92:95], v[86:89], v[44:47], v[92:95]
  s_waitcnt vmcnt(6)
  buffer_load_dwordx4 v6, s[12:15], s45 offen offset:2048 nt lds
  ds_read_b128 v[32:35], v12 offset:8192
  ds_read_b128 v[36:39], v12 offset:8448
  ds_read_b128 v[40:43], v12 offset:8704
  ds_read_b128 v[44:47], v12 offset:8960
  v_fma_f32 v56, v56, s48, -v97
  v_fma_f32 v57, v57, s48, -v97
  v_fma_f32 v58, v58, s48, -v97
  v_fma_f32 v59, v59, s48, -v97
  v_exp_f32 v56, v56
  v_exp_f32 v57, v57
  v_exp_f32 v58, v58
  v_exp_f32 v59, v59
  s_nop 0
  v_cvt_pk_bf16_f32 v80, v56, v57
  v_cvt_pk_bf16_f32 v81, v58, v59
  v_add_f32 v106, v56, v57
  v_add_f32 v107, v58, v59
  v_add_f32 v91, v91, v106
  v_add_f32 v91, v91, v107
  v_perm_b32 v82, v80, v80, v98
  v_perm_b32 v83, v80, v80, v99
  v_perm_b32 v84, v80, v80, v100
  v_perm_b32 v85, v80, v80, v101
  s_waitcnt lgkmcnt(3)
  s_nop 0
  v_mfma_f32_16x16x32_bf16 v[92:95], v[82:85], v[32:35], v[92:95]
  s_waitcnt vmcnt(6)
  buffer_load_dwordx4 v6, s[12:15], s45 offen offset:3072 nt lds
  v_perm_b32 v86, v80, v80, v102
  v_perm_b32 v87, v80, v80, v103
  v_perm_b32 v88, v80, v80, v104
  v_perm_b32 v89, v80, v80, v105
  s_waitcnt lgkmcnt(2)
  s_nop 0
  v_mfma_f32_16x16x32_bf16 v[92:95], v[86:89], v[36:39], v[92:95]
  s_add_u32 s45, s44, 69632
  s_add_u32 m0, s46, 20480
  s_waitcnt vmcnt(6)
  buffer_load_dwordx4 v6, s[12:15], s45 offen offset:0 nt lds
  v_perm_b32 v82, v81, v81, v98
  v_perm_b32 v83, v81, v81, v99
  v_perm_b32 v84, v81, v81, v100
  v_perm_b32 v85, v81, v81, v101
  s_waitcnt lgkmcnt(1)
  s_nop 0
  v_mfma_f32_16x16x32_bf16 v[92:95], v[82:85], v[40:43], v[92:95]
  s_waitcnt vmcnt(6)
  buffer_load_dwordx4 v6, s[12:15], s45 offen offset:1024 nt lds
  v_perm_b32 v86, v81, v81, v102
  v_perm_b32 v87, v81, v81, v103
  v_perm_b32 v88, v81, v81, v104
  v_perm_b32 v89, v81, v81, v105
  s_waitcnt lgkmcnt(0)
  s_nop 0
  v_mfma_f32_16x16x32_bf16 v[92:95], v[86:89], v[44:47], v[92:95]
  s_waitcnt vmcnt(6)
  buffer_load_dwordx4 v6, s[12:15], s45 offen offset:2048 nt lds
  ds_read_b128 v[32:35], v12 offset:12288
  ds_read_b128 v[36:39], v12 offset:12544
  ds_read_b128 v[40:43], v12 offset:12800
  ds_read_b128 v[44:47], v12 offset:13056
  v_fma_f32 v60, v60, s48, -v97
  v_fma_f32 v61, v61, s48, -v97
  v_fma_f32 v62, v62, s48, -v97
  v_fma_f32 v63, v63, s48, -v97
  v_exp_f32 v60, v60
  v_exp_f32 v61, v61
  v_exp_f32 v62, v62
  v_exp_f32 v63, v63
  s_nop 0
  v_cvt_pk_bf16_f32 v80, v60, v61
  v_cvt_pk_bf16_f32 v81, v62, v63
  v_add_f32 v106, v60, v61
  v_add_f32 v107, v62, v63
  v_add_f32 v91, v91, v106
  v_add_f32 v91, v91, v107
  v_perm_b32 v82, v80, v80, v98
  v_perm_b32 v83, v80, v80, v99
  v_perm_b32 v84, v80, v80, v100
  v_perm_b32 v85, v80, v80, v101
  s_waitcnt lgkmcnt(3)
  s_nop 0
  v_mfma_f32_16x16x32_bf16 v[92:95], v[82:85], v[32:35], v[92:95]
  s_waitcnt vmcnt(6)
  buffer_load_dwordx4 v6, s[12:15], s45 offen offset:3072 nt lds
  v_perm_b32 v86, v80, v80, v102
  v_perm_b32 v87, v80, v80, v103
  v_perm_b32 v88, v80, v80, v104
  v_perm_b32 v89, v80, v80, v105
  s_waitcnt lgkmcnt(2)
  s_nop 0
  v_mfma_f32_16x16x32_bf16 v[92:95], v[86:89], v[36:39], v[92:95]
  s_add_u32 s45, s44, 98304
  s_add_u32 m0, s46, 24576
  s_waitcnt vmcnt(6)
  buffer_load_dwordx4 v6, s[12:15], s45 offen offset:0 nt lds
  v_perm_b32 v82, v81, v81, v98
  v_perm_b32 v83, v81, v81, v99
  v_perm_b32 v84, v81, v81, v100
  v_perm_b32 v85, v81, v81, v101
  s_waitcnt lgkmcnt(1)
  s_nop 0
  v_mfma_f32_16x16x32_bf16 v[92:95], v[82:85], v[40:43], v[92:95]
  s_waitcnt vmcnt(6)
  buffer_load_dwordx4 v6, s[12:15], s45 offen offset:1024 nt lds
  v_perm_b32 v86, v81, v81, v102
  v_perm_b32 v87, v81, v81, v103
  v_perm_b32 v88, v81, v81, v104
  v_perm_b32 v89, v81, v81, v105
  s_waitcnt lgkmcnt(0)
  s_nop 0
  v_mfma_f32_16x16x32_bf16 v[92:95], v[86:89], v[44:47], v[92:95]
  s_waitcnt vmcnt(6)
  buffer_load_dwordx4 v6, s[12:15], s45 offen offset:2048 nt lds
  ds_read_b128 v[32:35], v12 offset:16384
  ds_read_b128 v[36:39], v12 offset:16640
  ds_read_b128 v[40:43], v12 offset:16896
  ds_read_b128 v[44:47], v12 offset:17152
  v_fma_f32 v64, v64, s48, -v97
  v_fma_f32 v65, v65, s48, -v97
  v_fma_f32 v66, v66, s48, -v97
  v_fma_f32 v67, v67, s48, -v97
  v_exp_f32 v64, v64
  v_exp_f32 v65, v65
  v_exp_f32 v66, v66
  v_exp_f32 v67, v67
  s_nop 0
  v_cvt_pk_bf16_f32 v80, v64, v65
  v_cvt_pk_bf16_f32 v81, v66, v67
  v_add_f32 v106, v64, v65
  v_add_f32 v107, v66, v67
  v_add_f32 v91, v91, v106
  v_add_f32 v91, v91, v107
  v_perm_b32 v82, v80, v80, v98
  v_perm_b32 v83, v80, v80, v99
  v_perm_b32 v84, v80, v80, v100
  v_perm_b32 v85, v80, v80, v101
  s_waitcnt lgkmcnt(3)
  s_nop 0
  v_mfma_f32_16x16x32_bf16 v[92:95], v[82:85], v[32:35], v[92:95]
  s_waitcnt vmcnt(6)
  buffer_load_dwordx4 v6, s[12:15], s45 offen offset:3072 nt lds
  v_perm_b32 v86, v80, v80, v102
  v_perm_b32 v87, v80, v80, v103
  v_perm_b32 v88, v80, v80, v104
  v_perm_b32 v89, v80, v80, v105
  s_waitcnt lgkmcnt(2)
  s_nop 0
  v_mfma_f32_16x16x32_bf16 v[92:95], v[86:89], v[36:39], v[92:95]
  s_add_u32 s45, s44, 102400
  s_add_u32 m0, s46, 28672
  s_waitcnt vmcnt(6)
  buffer_load_dwordx4 v6, s[12:15], s45 offen offset:0 nt lds
  v_perm_b32 v82, v81, v81, v98
  v_perm_b32 v83, v81, v81, v99
  v_perm_b32 v84, v81, v81, v100
  v_perm_b32 v85, v81, v81, v101
  s_waitcnt lgkmcnt(1)
  s_nop 0
  v_mfma_f32_16x16x32_bf16 v[92:95], v[82:85], v[40:43], v[92:95]
  s_waitcnt vmcnt(6)
  buffer_load_dwordx4 v6, s[12:15], s45 offen offset:1024 nt lds
  v_perm_b32 v86, v81, v81, v102
  v_perm_b32 v87, v81, v81, v103
  v_perm_b32 v88, v81, v81, v104
  v_perm_b32 v89, v81, v81, v105
  s_waitcnt lgkmcnt(0)
  s_nop 0
  v_mfma_f32_16x16x32_bf16 v[92:95], v[86:89], v[44:47], v[92:95]
  s_waitcnt vmcnt(6)
  buffer_load_dwordx4 v6, s[12:15], s45 offen offset:2048 nt lds
  ds_read_b128 v[32:35], v12 offset:20480
  ds_read_b128 v[36:39], v12 offset:20736
  ds_read_b128 v[40:43], v12 offset:20992
  ds_read_b128 v[44:47], v12 offset:21248
  v_fma_f32 v68, v68, s48, -v97
  v_fma_f32 v69, v69, s48, -v97
  v_fma_f32 v70, v70, s48, -v97
  v_fma_f32 v71, v71, s48, -v97
  v_exp_f32 v68, v68
  v_exp_f32 v69, v69
  v_exp_f32 v70, v70
  v_exp_f32 v71, v71
  s_nop 0
  v_cvt_pk_bf16_f32 v80, v68, v69
  v_cvt_pk_bf16_f32 v81, v70, v71
  v_add_f32 v106, v68, v69
  v_add_f32 v107, v70, v71
  v_add_f32 v91, v91, v106
  v_add_f32 v91, v91, v107
  v_perm_b32 v82, v80, v80, v98
  v_perm_b32 v83, v80, v80, v99
  v_perm_b32 v84, v80, v80, v100
  v_perm_b32 v85, v80, v80, v101
  s_waitcnt lgkmcnt(3)
  s_nop 0
  v_mfma_f32_16x16x32_bf16 v[92:95], v[82:85], v[32:35], v[92:95]
  s_waitcnt vmcnt(6)
  buffer_load_dwordx4 v6, s[12:15], s45 offen offset:3072 nt lds
  s_add_u32 s44, s44, 131072
  v_perm_b32 v86, v80, v80, v102
  v_perm_b32 v87, v80, v80, v103
  v_perm_b32 v88, v80, v80, v104
  v_perm_b32 v89, v80, v80, v105
  s_waitcnt lgkmcnt(2)
  s_nop 0
  v_mfma_f32_16x16x32_bf16 v[92:95], v[86:89], v[36:39], v[92:95]
  v_perm_b32 v82, v81, v81, v98
  v_perm_b32 v83, v81, v81, v99
  v_perm_b32 v84, v81, v81, v100
  v_perm_b32 v85, v81, v81, v101
  s_waitcnt lgkmcnt(1)
  s_nop 0
  v_mfma_f32_16x16x32_bf16 v[92:95], v[82:85], v[40:43], v[92:95]
  v_perm_b32 v86, v81, v81, v102
  v_perm_b32 v87, v81, v81, v103
  v_perm_b32 v88, v81, v81, v104
  v_perm_b32 v89, v81, v81, v105
  s_waitcnt lgkmcnt(0)
  s_nop 0
  v_mfma_f32_16x16x32_bf16 v[92:95], v[86:89], v[44:47], v[92:95]
  s_waitcnt vmcnt(4)
  ds_read_b128 v[32:35], v12 offset:24576
  ds_read_b128 v[36:39], v12 offset:24832
  ds_read_b128 v[40:43], v12 offset:25088
  ds_read_b128 v[44:47], v12 offset:25344
  v_fma_f32 v72, v72, s48, -v97
  v_fma_f32 v73, v73, s48, -v97
  v_fma_f32 v74, v74, s48, -v97
  v_fma_f32 v75, v75, s48, -v97
  v_exp_f32 v72, v72
  v_exp_f32 v73, v73
  v_exp_f32 v74, v74
  v_exp_f32 v75, v75
  s_nop 0
  v_cvt_pk_bf16_f32 v80, v72, v73
  v_cvt_pk_bf16_f32 v81, v74, v75
  v_add_f32 v106, v72, v73
  v_add_f32 v107, v74, v75
  v_add_f32 v91, v91, v106
  v_add_f32 v91, v91, v107
  v_perm_b32 v82, v80, v80, v98
  v_perm_b32 v83, v80, v80, v99
  v_perm_b32 v84, v80, v80, v100
  v_perm_b32 v85, v80, v80, v101
  s_waitcnt lgkmcnt(3)
  s_nop 0
  v_mfma_f32_16x16x32_bf16 v[92:95], v[82:85], v[32:35], v[92:95]
  v_perm_b32 v86, v80, v80, v102
  v_perm_b32 v87, v80, v80, v103
  v_perm_b32 v88, v80, v80, v104
  v_perm_b32 v89, v80, v80, v105
  s_waitcnt lgkmcnt(2)
  s_nop 0
  v_mfma_f32_16x16x32_bf16 v[92:95], v[86:89], v[36:39], v[92:95]
  v_perm_b32 v82, v81, v81, v98
  v_perm_b32 v83, v81, v81, v99
  v_perm_b32 v84, v81, v81, v100
  v_perm_b32 v85, v81, v81, v101
  s_waitcnt lgkmcnt(1)
  s_nop 0
  v_mfma_f32_16x16x32_bf16 v[92:95], v[82:85], v[40:43], v[92:95]
  v_perm_b32 v86, v81, v81, v102
  v_perm_b32 v87, v81, v81, v103
  v_perm_b32 v88, v81, v81, v104
  v_perm_b32 v89, v81, v81, v105
  s_waitcnt lgkmcnt(0)
  s_nop 0
  v_mfma_f32_16x16x32_bf16 v[92:95], v[86:89], v[44:47], v[92:95]
  s_waitcnt vmcnt(0)
  ds_read_b128 v[32:35], v12 offset:28672
  ds_read_b128 v[36:39], v12 offset:28928
  ds_read_b128 v[40:43], v12 offset:29184
  ds_read_b128 v[44:47], v12 offset:29440
  v_fma_f32 v76, v76, s48, -v97
  v_fma_f32 v77, v77, s48, -v97
  v_fma_f32 v78, v78, s48, -v97
  v_fma_f32 v79, v79, s48, -v97
  v_exp_f32 v76, v76
  v_exp_f32 v77, v77
  v_exp_f32 v78, v78
  v_exp_f32 v79, v79
  s_nop 0
  v_cvt_pk_bf16_f32 v80, v76, v77
  v_cvt_pk_bf16_f32 v81, v78, v79
  v_add_f32 v106, v76, v77
  v_add_f32 v107, v78, v79
  v_add_f32 v91, v91, v106
  v_add_f32 v91, v91, v107
  v_perm_b32 v82, v80, v80, v98
  v_perm_b32 v83, v80, v80, v99
  v_perm_b32 v84, v80, v80, v100
  v_perm_b32 v85, v80, v80, v101
  s_waitcnt lgkmcnt(3)
  s_nop 0
  v_mfma_f32_16x16x32_bf16 v[92:95], v[82:85], v[32:35], v[92:95]
  v_perm_b32 v86, v80, v80, v102
  v_perm_b32 v87, v80, v80, v103
  v_perm_b32 v88, v80, v80, v104
  v_perm_b32 v89, v80, v80, v105
  s_waitcnt lgkmcnt(2)
  s_nop 0
  v_mfma_f32_16x16x32_bf16 v[92:95], v[86:89], v[36:39], v[92:95]
  v_perm_b32 v82, v81, v81, v98
  v_perm_b32 v83, v81, v81, v99
  v_perm_b32 v84, v81, v81, v100
  v_perm_b32 v85, v81, v81, v101
  s_waitcnt lgkmcnt(1)
  s_nop 0
  v_mfma_f32_16x16x32_bf16 v[92:95], v[82:85], v[40:43], v[92:95]
  v_perm_b32 v86, v81, v81, v102
  v_perm_b32 v87, v81, v81, v103
  v_perm_b32 v88, v81, v81, v104
  v_perm_b32 v89, v81, v81, v105
  s_waitcnt lgkmcnt(0)
  s_nop 0
  v_mfma_f32_16x16x32_bf16 v[92:95], v[86:89], v[44:47], v[92:95]
  s_branch L_snext
L_ver5:
  s_add_u32 s45, s44, 32768
  s_add_u32 m0, s46, 8192
  s_waitcnt vmcnt(4)
  buffer_load_dwordx4 v4, s[8:11], s45 offen offset:2048 nt lds
  ds_read_b128 v[32:35], v8 offset:0
  ds_read_b128 v[36:39], v9 offset:0
  ds_read_b128 v[40:43], v10 offset:0
  ds_read_b128 v[44:47], v11 offset:0
  s_waitcnt vmcnt(4)
  buffer_load_dwordx4 v5, s[8:11], s45 offen offset:3072 nt lds
  s_waitcnt lgkmcnt(3)
  v_mfma_f32_16x16x32_bf16 v[48:51], v[32:35], v[16:19], 0
  s_waitcnt lgkmcnt(2)
  v_mfma_f32_16x16x32_bf16 v[48:51], v[36:39], v[20:23], v[48:51]
  s_waitcnt lgkmcnt(1)
  v_mfma_f32_16x16x32_bf16 v[48:51], v[40:43], v[24:27], v[48:51]
  s_waitcnt lgkmcnt(0)
  v_mfma_f32_16x16x32_bf16 v[48:51], v[44:47], v[28:31], v[48:51]
  s_add_u32 s45, s44, 36864
  s_add_u32 m0, s46, 12288
  s_waitcnt vmcnt(4)
  buffer_load_dwordx4 v2, s[8:11], s45 offen offset:0 nt lds
  s_nop 7
  v_cvt_pk_bf16_f32 v106, v48, v49
  v_cvt_pk_bf16_f32 v107, v50, v51
  v_lshlrev_b32 v48, 16, v106
  v_and_b32 v49, s80, v106
  v_lshlrev_b32 v50, 16, v107
  v_and_b32 v51, s80, v107
  v_mul_f32 v48, s81, v48
  v_mul_f32 v49, s81, v49
  v_mul_f32 v50, s81, v50
  v_mul_f32 v51, s81, v51
  v_cvt_pk_bf16_f32 v106, v48, v49
  v_cvt_pk_bf16_f32 v107, v50, v51
  v_lshlrev_b32 v48, 16, v106
  v_and_b32 v49, s80, v106
  v_lshlrev_b32 v50, 16, v107
  v_and_b32 v51, s80, v107
  v_max3_f32 v14, v90, v48, v49
  v_max3_f32 v14, v14, v50, v51
  s_waitcnt vmcnt(4)
  buffer_load_dwordx4 v3, s[8:11], s45 offen offset:1024 nt lds
  s_waitcnt vmcnt(4)
  buffer_load_dwordx4 v4, s[8:11], s45 offen offset:2048 nt lds
  ds_read_b128 v[32:35], v8 offset:4096
  ds_read_b128 v[36:39], v9 offset:4096
  ds_read_b128 v[40:43], v10 offset:4096
  ds_read_b128 v[44:47], v11 offset:4096
  s_waitcnt vmcnt(4)
  buffer_load_dwordx4 v5, s[8:11], s45 offen offset:3072 nt lds
  s_waitcnt lgkmcnt(3)
  v_mfma_f32_16x16x32_bf16 v[52:55], v[32:35], v[16:19], 0
  s_waitcnt lgkmcnt(2)
  v_mfma_f32_16x16x32_bf16 v[52:55], v[36:39], v[20:23], v[52:55]
  s_waitcnt lgkmcnt(1)
  v_mfma_f32_16x16x32_bf16 v[52:55], v[40:43], v[24:27], v[52:55]
  s_waitcnt lgkmcnt(0)
  v_mfma_f32_16x16x32_bf16 v[52:55], v[44:47], v[28:31], v[52:55]
  s_add_u32 s45, s44, 65536
  s_add_u32 m0, s46, 16384
  s_waitcnt vmcnt(4)
  buffer_load_dwordx4 v2, s[8:11], s45 offen offset:0 nt lds
  s_nop 7
  v_cvt_pk_bf16_f32 v106, v52, v53
  v_cvt_pk_bf16_f32 v107, v54, v55
  v_lshlrev_b32 v52, 16, v106
  v_and_b32 v53, s80, v106
  v_lshlrev_b32 v54, 16, v107
  v_and_b32 v55, s80, v107
  v_mul_f32 v52, s81, v52
  v_mul_f32 v53, s81, v53
  v_mul_f32 v54, s81, v54
  v_mul_f32 v55, s81, v55
  v_cvt_pk_bf16_f32 v106, v52, v53
  v_cvt_pk_bf16_f32 v107, v54, v55
  v_lshlrev_b32 v52, 16, v106
  v_and_b32 v53, s80, v106
  v_lshlrev_b32 v54, 16, v107
  v_and_b32 v55, s80, v107
  v_max3_f32 v14, v14, v52, v53
  v_max3_f32 v14, v14, v54, v55
  s_waitcnt vmcnt(4)
  buffer_load_dwordx4 v3, s[8:11], s45 offen offset:1024 nt lds
  s_waitcnt vmcnt(4)
  buffer_load_dwordx4 v4, s[8:11], s45 offen offset:2048 nt lds
  ds_read_b128 v[32:35], v8 offset:8192
  ds_read_b128 v[36:39], v9 offset:8192
  ds_read_b128 v[40:43], v10 offset:8192
  ds_read_b128 v[44:47], v11 offset:8192
  s_waitcnt vmcnt(4)
  buffer_load_dwordx4 v5, s[8:11], s45 offen offset:3072 nt lds
  s_waitcnt lgkmcnt(3)
  v_mfma_f32_16x16x32_bf16 v[56:59], v[32:35], v[16:19], 0
  s_waitcnt lgkmcnt(2)
  v_mfma_f32_16x16x32_bf16 v[56:59], v[36:39], v[20:23], v[56:59]
  s_waitcnt lgkmcnt(1)
  v_mfma_f32_16x16x32_bf16 v[56:59], v[40:43], v[24:27], v[56:59]
  s_waitcnt lgkmcnt(0)
  v_mfma_f32_16x16x32_bf16 v[56:59], v[44:47], v[28:31], v[56:59]
  s_add_u32 s45, s44, 69632
  s_add_u32 m0, s46, 20480
  s_waitcnt vmcnt(4)
  buffer_load_dwordx4 v2, s[8:11], s45 offen offset:0 nt lds
  s_nop 7
  v_cvt_pk_bf16_f32 v106, v56, v57
  v_cvt_pk_bf16_f32 v107, v58, v59
  v_lshlrev_b32 v56, 16, v106
  v_and_b32 v57, s80, v106
  v_lshlrev_b32 v58, 16, v107
  v_and_b32 v59, s80, v107
  v_mul_f32 v56, s81, v56
  v_mul_f32 v57, s81, v57
  v_mul_f32 v58, s81, v58
  v_mul_f32 v59, s81, v59
  v_cvt_pk_bf16_f32 v106, v56, v57
  v_cvt_pk_bf16_f32 v107, v58, v59
  v_lshlrev_b32 v56, 16, v106
  v_and_b32 v57, s80, v106
  v_lshlrev_b32 v58, 16, v107
  v_and_b32 v59, s80, v107
  v_max3_f32 v14, v14, v56, v57
  v_max3_f32 v14, v14, v58, v59
  s_waitcnt vmcnt(4)
  buffer_load_dwordx4 v3, s[8:11], s45 offen offset:1024 nt lds
  s_waitcnt vmcnt(4)
  buffer_load_dwordx4 v4, s[8:11], s45 offen offset:2048 nt lds
  ds_read_b128 v[32:35], v8 offset:12288
  ds_read_b128 v[36:39], v9 offset:12288
  ds_read_b128 v[40:43], v10 offset:12288
  ds_read_b128 v[44:47], v11 offset:12288
  s_waitcnt vmcnt(4)
  buffer_load_dwordx4 v5, s[8:11], s45 offen offset:3072 nt lds
  s_waitcnt lgkmcnt(3)
  v_mfma_f32_16x16x32_bf16 v[60:63], v[32:35], v[16:19], 0
  s_waitcnt lgkmcnt(2)
  v_mfma_f32_16x16x32_bf16 v[60:63], v[36:39], v[20:23], v[60:63]
  s_waitcnt lgkmcnt(1)
  v_mfma_f32_16x16x32_bf16 v[60:63], v[40:43], v[24:27], v[60:63]
  s_waitcnt lgkmcnt(0)
  v_mfma_f32_16x16x32_bf16 v[60:63], v[44:47], v[28:31], v[60:63]
  s_add_u32 s45, s44, 98304
  s_add_u32 m0, s46, 24576
  s_waitcnt vmcnt(4)
  buffer_load_dwordx4 v2, s[8:11], s45 offen offset:0 nt lds
  s_nop 7
  v_cvt_pk_bf16_f32 v106, v60, v61
  v_cvt_pk_bf16_f32 v107, v62, v63
  v_lshlrev_b32 v60, 16, v106
  v_and_b32 v61, s80, v106
  v_lshlrev_b32 v62, 16, v107
  v_and_b32 v63, s80, v107
  v_mul_f32 v60, s81, v60
  v_mul_f32 v61, s81, v61
  v_mul_f32 v62, s81, v62
  v_mul_f32 v63, s81, v63
  v_cvt_pk_bf16_f32 v106, v60, v61
  v_cvt_pk_bf16_f32 v107, v62, v63
  v_lshlrev_b32 v60, 16, v106
  v_and_b32 v61, s80, v106
  v_lshlrev_b32 v62, 16, v107
  v_and_b32 v63, s80, v107
  v_max3_f32 v14, v14, v60, v61
  v_max3_f32 v14, v14, v62, v63
  s_waitcnt vmcnt(4)
  buffer_load_dwordx4 v3, s[8:11], s45 offen offset:1024 nt lds
  s_waitcnt vmcnt(4)
  buffer_load_dwordx4 v4, s[8:11], s45 offen offset:2048 nt lds
  ds_read_b128 v[32:35], v8 offset:16384
  ds_read_b128 v[36:39], v9 offset:16384
  ds_read_b128 v[40:43], v10 offset:16384
  ds_read_b128 v[44:47], v11 offset:16384
  s_waitcnt vmcnt(4)
  buffer_load_dwordx4 v5, s[8:11], s45 offen offset:3072 nt lds
  s_waitcnt lgkmcnt(3)
  v_mfma_f32_16x16x32_bf16 v[64:67], v[32:35], v[16:19], 0
  s_waitcnt lgkmcnt(2)
  v_mfma_f32_16x16x32_bf16 v[64:67], v[36:39], v[20:23], v[64:67]
  s_waitcnt lgkmcnt(1)
  v_mfma_f32_16x16x32_bf16 v[64:67], v[40:43], v[24:27], v[64:67]
  s_waitcnt lgkmcnt(0)
  v_mfma_f32_16x16x32_bf16 v[64:67], v[44:47], v[28:31], v[64:67]
  s_add_u32 s45, s44, 102400
  s_add_u32 m0, s46, 28672
  s_waitcnt vmcnt(4)
  buffer_load_dwordx4 v2, s[8:11], s45 offen offset:0 nt lds
  s_nop 7
  v_cvt_pk_bf16_f32 v106, v64, v65
  v_cvt_pk_bf16_f32 v107, v66, v67
  v_lshlrev_b32 v64, 16, v106
  v_and_b32 v65, s80, v106
  v_lshlrev_b32 v66, 16, v107
  v_and_b32 v67, s80, v107
  v_mul_f32 v64, s81, v64
  v_mul_f32 v65, s81, v65
  v_mul_f32 v66, s81, v66
  v_mul_f32 v67, s81, v67
  v_cvt_pk_bf16_f32 v106, v64, v65
  v_cvt_pk_bf16_f32 v107, v66, v67
  v_lshlrev_b32 v64, 16, v106
  v_and_b32 v65, s80, v106
  v_lshlrev_b32 v66, 16, v107
  v_and_b32 v67, s80, v107
  v_max3_f32 v14, v14, v64, v65
  v_max3_f32 v14, v14, v66, v67
  s_waitcnt vmcnt(4)
  buffer_load_dwordx4 v3, s[8:11], s45 offen offset:1024 nt lds
  s_waitcnt vmcnt(4)
  buffer_load_dwordx4 v4, s[8:11], s45 offen offset:2048 nt lds
  ds_read_b128 v[32:35], v8 offset:20480
  ds_read_b128 v[36:39], v9 offset:20480
  ds_read_b128 v[40:43], v10 offset:20480
  ds_read_b128 v[44:47], v11 offset:20480
  s_waitcnt vmcnt(4)
  buffer_load_dwordx4 v5, s[8:11], s45 offen offset:3072 nt lds
  s_waitcnt lgkmcnt(3)
  v_mfma_f32_16x16x32_bf16 v[68:71], v[32:35], v[16:19], 0
  s_waitcnt lgkmcnt(2)
  v_mfma_f32_16x16x32_bf16 v[68:71], v[36:39], v[20:23], v[68:71]
  s_waitcnt lgkmcnt(1)
  v_mfma_f32_16x16x32_bf16 v[68:71], v[40:43], v[24:27], v[68:71]
  s_waitcnt lgkmcnt(0)
  v_mfma_f32_16x16x32_bf16 v[68:71], v[44:47], v[28:31], v[68:71]
  s_add_u32 s45, s44, 0
  s_add_u32 m0, s46, 0
  s_waitcnt vmcnt(4)
  buffer_load_dwordx4 v6, s[12:15], s45 offen offset:0 nt lds
  s_nop 7
  v_cvt_pk_bf16_f32 v106, v68, v69
  v_cvt_pk_bf16_f32 v107, v70, v71
  v_lshlrev_b32 v68, 16, v106
  v_and_b32 v69, s80, v106
  v_lshlrev_b32 v70, 16, v107
  v_and_b32 v71, s80, v107
  v_mul_f32 v68, s81, v68
  v_mul_f32 v69, s81, v69
  v_mul_f32 v70, s81, v70
  v_mul_f32 v71, s81, v71
  v_cvt_pk_bf16_f32 v106, v68, v69
  v_cvt_pk_bf16_f32 v107, v70, v71
  v_lshlrev_b32 v68, 16, v106
  v_and_b32 v69, s80, v106
  v_lshlrev_b32 v70, 16, v107
  v_and_b32 v71, s80, v107
  v_max3_f32 v14, v14, v68, v69
  v_max3_f32 v14, v14, v70, v71
  s_waitcnt vmcnt(4)
  buffer_load_dwordx4 v6, s[12:15], s45 offen offset:1024 nt lds
  s_waitcnt vmcnt(4)
  buffer_load_dwordx4 v6, s[12:15], s45 offen offset:2048 nt lds
  ds_read_b128 v[32:35], v8 offset:24576
  ds_read_b128 v[36:39], v9 offset:24576
  ds_read_b128 v[40:43], v10 offset:24576
  ds_read_b128 v[44:47], v11 offset:24576
  s_waitcnt vmcnt(4)
  buffer_load_dwordx4 v6, s[12:15], s45 offen offset:3072 nt lds
  s_waitcnt lgkmcnt(3)
  v_mfma_f32_16x16x32_bf16 v[72:75], v[32:35], v[16:19], 0
  s_waitcnt lgkmcnt(2)
  v_mfma_f32_16x16x32_bf16 v[72:75], v[36:39], v[20:23], v[72:75]
  s_waitcnt lgkmcnt(1)
  v_mfma_f32_16x16x32_bf16 v[72:75], v[40:43], v[24:27], v[72:75]
  s_waitcnt lgkmcnt(0)
  v_mfma_f32_16x16x32_bf16 v[72:75], v[44:47], v[28:31], v[72:75]
  s_add_u32 s45, s44, 4096
  s_add_u32 m0, s46, 4096
  s_waitcnt vmcnt(4)
  buffer_load_dwordx4 v6, s[12:15], s45 offen offset:0 nt lds
  s_nop 7
  v_cvt_pk_bf16_f32 v106, v72, v73
  v_cvt_pk_bf16_f32 v107, v74, v75
  v_lshlrev_b32 v72, 16, v106
  v_and_b32 v73, s80, v106
  v_lshlrev_b32 v74, 16, v107
  v_and_b32 v75, s80, v107
  v_mul_f32 v72, s81, v72
  v_mul_f32 v73, s81, v73
  v_mul_f32 v74, s81, v74
  v_mul_f32 v75, s81, v75
  v_cvt_pk_bf16_f32 v106, v72, v73
  v_cvt_pk_bf16_f32 v107, v74, v75
  v_lshlrev_b32 v72, 16, v106
  v_and_b32 v73, s80, v106
  v_lshlrev_b32 v74, 16, v107
  v_and_b32 v75, s80, v107
  v_max3_f32 v14, v14, v72, v73
  v_max3_f32 v14, v14, v74, v75
  s_waitcnt vmcnt(4)
  buffer_load_dwordx4 v6, s[12:15], s45 offen offset:1024 nt lds
  s_waitcnt vmcnt(4)
  buffer_load_dwordx4 v6, s[12:15], s45 offen offset:2048 nt lds
  ds_read_b128 v[32:35], v8 offset:28672
  ds_read_b128 v[36:39], v9 offset:28672
  ds_read_b128 v[40:43], v10 offset:28672
  ds_read_b128 v[44:47], v11 offset:28672
  s_waitcnt vmcnt(4)
  buffer_load_dwordx4 v6, s[12:15], s45 offen offset:3072 nt lds
  s_waitcnt lgkmcnt(3)
  v_mfma_f32_16x16x32_bf16 v[76:79], v[32:35], v[16:19], 0
  s_waitcnt lgkmcnt(2)
  v_mfma_f32_16x16x32_bf16 v[76:79], v[36:39], v[20:23], v[76:79]
  s_waitcnt lgkmcnt(1)
  v_mfma_f32_16x16x32_bf16 v[76:79], v[40:43], v[24:27], v[76:79]
  s_waitcnt lgkmcnt(0)
  v_mfma_f32_16x16x32_bf16 v[76:79], v[44:47], v[28:31], v[76:79]
  s_add_u32 s45, s44, 32768
  s_add_u32 m0, s46, 8192
  s_waitcnt vmcnt(4)
  buffer_load_dwordx4 v6, s[12:15], s45 offen offset:0 nt lds
  s_nop 7
  v_cvt_pk_bf16_f32 v106, v76, v77
  v_cvt_pk_bf16_f32 v107, v78, v79
  v_lshlrev_b32 v76, 16, v106
  v_and_b32 v77, s80, v106
  v_lshlrev_b32 v78, 16, v107
  v_and_b32 v79, s80, v107
  v_mul_f32 v76, s81, v76
  v_mul_f32 v77, s81, v77
  v_mul_f32 v78, s81, v78
  v_mul_f32 v79, s81, v79
  v_cvt_pk_bf16_f32 v106, v76, v77
  v_cvt_pk_bf16_f32 v107, v78, v79
  v_lshlrev_b32 v76, 16, v106
  v_and_b32 v77, s80, v106
  v_lshlrev_b32 v78, 16, v107
  v_and_b32 v79, s80, v107
  v_max3_f32 v14, v14, v76, v77
  v_max3_f32 v14, v14, v78, v79
  s_waitcnt vmcnt(4)
  buffer_load_dwordx4 v6, s[12:15], s45 offen offset:1024 nt lds
  v_mov_b32 v106, v14
  s_nop 1
  v_permlane16_swap_b32 v14, v106
  s_nop 1
  v_max_f32 v14, v14, v106
  v_mov_b32 v106, v14
  s_nop 1
  v_permlane32_swap_b32 v14, v106
  s_nop 1
  v_max_f32 v14, v14, v106
  v_sub_f32 v96, v90, v14
  v_mul_f32 v97, s48, v14
  v_mul_f32 v96, s48, v96
  v_mov_b32 v90, v14
  v_exp_f32 v96, v96
  s_nop 0
  v_mul_f32 v92, v92, v96
  v_mul_f32 v93, v93, v96
  v_mul_f32 v94, v94, v96
  v_mul_f32 v95, v95, v96
  v_mul_f32 v91, v91, v96
  s_waitcnt vmcnt(4)
  buffer_load_dwordx4 v6, s[12:15], s45 offen offset:2048 nt lds
  ds_read_b128 v[32:35], v12 offset:0
  ds_read_b128 v[36:39], v12 offset:256
  ds_read_b128 v[40:43], v12 offset:512
  ds_read_b128 v[44:47], v12 offset:768
  v_fma_f32 v48, v48, s48, -v97
  v_fma_f32 v49, v49, s48, -v97
  v_fma_f32 v50, v50, s48, -v97
  v_fma_f32 v51, v51, s48, -v97
  v_exp_f32 v48, v48
  v_exp_f32 v49, v49
  v_exp_f32 v50, v50
  v_exp_f32 v51, v51
  s_nop 0
  v_cvt_pk_bf16_f32 v80, v48, v49
  v_cvt_pk_bf16_f32 v81, v50, v51
  v_add_f32 v106, v48, v49
  v_add_f32 v107, v50, v51
  v_add_f32 v91, v91, v106
  v_add_f32 v91, v91, v107
  v_perm_b32 v82, v80, v80, v98
  v_perm_b32 v83, v80, v80, v99
  v_perm_b32 v84, v80, v80, v100
  v_perm_b32 v85, v80, v80, v101
  s_waitcnt lgkmcnt(3)
  s_nop 0
  v_mfma_f32_16x16x32_bf16 v[92:95], v[82:85], v[32:35], v[92:95]
  s_waitcnt vmcnt(4)
  buffer_load_dwordx4 v6, s[12:15], s45 offen offset:3072 nt lds
  v_perm_b32 v86, v80, v80, v102
  v_perm_b32 v87, v80, v80, v103
  v_perm_b32 v88, v80, v80, v104
  v_perm_b32 v89, v80, v80, v105
  s_waitcnt lgkmcnt(2)
  s_nop 0
  v_mfma_f32_16x16x32_bf16 v[92:95], v[86:89], v[36:39], v[92:95]
  s_add_u32 s45, s44, 36864
  s_add_u32 m0, s46, 12288
  s_waitcnt vmcnt(4)
  buffer_load_dwordx4 v6, s[12:15], s45 offen offset:0 nt lds
  v_perm_b32 v82, v81, v81, v98
  v_perm_b32 v83, v81, v81, v99
  v_perm_b32 v84, v81, v81, v100
  v_perm_b32 v85, v81, v81, v101
  s_waitcnt lgkmcnt(1)
  s_nop 0
  v_mfma_f32_16x16x32_bf16 v[92:95], v[82:85], v[40:43], v[92:95]
  s_waitcnt vmcnt(4)
  buffer_load_dwordx4 v6, s[12:15], s45 offen offset:1024 nt lds
  v_perm_b32 v86, v81, v81, v102
  v_perm_b32 v87, v81, v81, v103
  v_perm_b32 v88, v81, v81, v104
  v_perm_b32 v89, v81, v81, v105
  s_waitcnt lgkmcnt(0)
  s_nop 0
  v_mfma_f32_16x16x32_bf16 v[92:95], v[86:89], v[44:47], v[92:95]
  s_waitcnt vmcnt(4)
  buffer_load_dwordx4 v6, s[12:15], s45 offen offset:2048 nt lds
  ds_read_b128 v[32:35], v12 offset:4096
  ds_read_b128 v[36:39], v12 offset:4352
  ds_read_b128 v[40:43], v12 offset:4608
  ds_read_b128 v[44:47], v12 offset:4864
  v_fma_f32 v52, v52, s48, -v97
  v_fma_f32 v53, v53, s48, -v97
  v_fma_f32 v54, v54, s48, -v97
  v_fma_f32 v55, v55, s48, -v97
  v_exp_f32 v52, v52
  v_exp_f32 v53, v53
  v_exp_f32 v54, v54
  v_exp_f32 v55, v55
  s_nop 0
  v_cvt_pk_bf16_f32 v80, v52, v53
  v_cvt_pk_bf16_f32 v81, v54, v55
  v_add_f32 v106, v52, v53
  v_add_f32 v107, v54, v55
  v_add_f32 v91, v91, v106
  v_add_f32 v91, v91, v107
  v_perm_b32 v82, v80, v80, v98
  v_perm_b32 v83, v80, v80, v99
  v_perm_b32 v84, v80, v80, v100
  v_perm_b32 v85, v80, v80, v101
  s_waitcnt lgkmcnt(3)
  s_nop 0
  v_mfma_f32_16x16x32_bf16 v[92:95], v[82:85], v[32:35], v[92:95]
  s_waitcnt vmcnt(4)
  buffer_load_dwordx4 v6, s[12:15], s45 offen offset:3072 nt lds
  v_perm_b32 v86, v80, v80, v102
  v_perm_b32 v87, v80, v80, v103
  v_perm_b32 v88, v80, v80, v104
  v_perm_b32 v89, v80, v80, v105
  s_waitcnt lgkmcnt(2)
  s_nop 0
  v_mfma_f32_16x16x32_bf16 v[92:95], v[86:89], v[36:39], v[92:95]
  s_add_u32 s45, s44, 65536
  s_add_u32 m0, s46, 16384
  s_waitcnt vmcnt(4)
  buffer_load_dwordx4 v6, s[12:15], s45 offen offset:0 nt lds
  v_perm_b32 v82, v81, v81, v98
  v_perm_b32 v83, v81, v81, v99
  v_perm_b32 v84, v81, v81, v100
  v_perm_b32 v85, v81, v81, v101
  s_waitcnt lgkmcnt(1)
  s_nop 0
  v_mfma_f32_16x16x32_bf16 v[92:95], v[82:85], v[40:43], v[92:95]
  s_waitcnt vmcnt(4)
  buffer_load_dwordx4 v6, s[12:15], s45 offen offset:1024 nt lds
  v_perm_b32 v86, v81, v81, v102
  v_perm_b32 v87, v81, v81, v103
  v_perm_b32 v88, v81, v81, v104
  v_perm_b32 v89, v81, v81, v105
  s_waitcnt lgkmcnt(0)
  s_nop 0
  v_mfma_f32_16x16x32_bf16 v[92:95], v[86:89], v[44:47], v[92:95]
  s_waitcnt vmcnt(4)
  buffer_load_dwordx4 v6, s[12:15], s45 offen offset:2048 nt lds
  ds_read_b128 v[32:35], v12 offset:8192
  ds_read_b128 v[36:39], v12 offset:8448
  ds_read_b128 v[40:43], v12 offset:8704
  ds_read_b128 v[44:47], v12 offset:8960
  v_fma_f32 v56, v56, s48, -v97
  v_fma_f32 v57, v57, s48, -v97
  v_fma_f32 v58, v58, s48, -v97
  v_fma_f32 v59, v59, s48, -v97
  v_exp_f32 v56, v56
  v_exp_f32 v57, v57
  v_exp_f32 v58, v58
  v_exp_f32 v59, v59
  s_nop 0
  v_cvt_pk_bf16_f32 v80, v56, v57
  v_cvt_pk_bf16_f32 v81, v58, v59
  v_add_f32 v106, v56, v57
  v_add_f32 v107, v58, v59
  v_add_f32 v91, v91, v106
  v_add_f32 v91, v91, v107
  v_perm_b32 v82, v80, v80, v98
  v_perm_b32 v83, v80, v80, v99
  v_perm_b32 v84, v80, v80, v100
  v_perm_b32 v85, v80, v80, v101
  s_waitcnt lgkmcnt(3)
  s_nop 0
  v_mfma_f32_16x16x32_bf16 v[92:95], v[82:85], v[32:35], v[92:95]
  s_waitcnt vmcnt(4)
  buffer_load_dwordx4 v6, s[12:15], s45 offen offset:3072 nt lds
  v_perm_b32 v86, v80, v80, v102
  v_perm_b32 v87, v80, v80, v103
  v_perm_b32 v88, v80, v80, v104
  v_perm_b32 v89, v80, v80, v105
  s_waitcnt lgkmcnt(2)
  s_nop 0
  v_mfma_f32_16x16x32_bf16 v[92:95], v[86:89], v[36:39], v[92:95]
  s_add_u32 s45, s44, 69632
  s_add_u32 m0, s46, 20480
  s_waitcnt vmcnt(4)
  buffer_load_dwordx4 v6, s[12:15], s45 offen offset:0 nt lds
  v_perm_b32 v82, v81, v81, v98
  v_perm_b32 v83, v81, v81, v99
  v_perm_b32 v84, v81, v81, v100
  v_perm_b32 v85, v81, v81, v101
  s_waitcnt lgkmcnt(1)
  s_nop 0
  v_mfma_f32_16x16x32_bf16 v[92:95], v[82:85], v[40:43], v[92:95]
  s_waitcnt vmcnt(4)
  buffer_load_dwordx4 v6, s[12:15], s45 offen offset:1024 nt lds
  v_perm_b32 v86, v81, v81, v102
  v_perm_b32 v87, v81, v81, v103
  v_perm_b32 v88, v81, v81, v104
  v_perm_b32 v89, v81, v81, v105
  s_waitcnt lgkmcnt(0)
  s_nop 0
  v_mfma_f32_16x16x32_bf16 v[92:95], v[86:89], v[44:47], v[92:95]
  s_waitcnt vmcnt(4)
  buffer_load_dwordx4 v6, s[12:15], s45 offen offset:2048 nt lds
  ds_read_b128 v[32:35], v12 offset:12288
  ds_read_b128 v[36:39], v12 offset:12544
  ds_read_b128 v[40:43], v12 offset:12800
  ds_read_b128 v[44:47], v12 offset:13056
  v_fma_f32 v60, v60, s48, -v97
  v_fma_f32 v61, v61, s48, -v97
  v_fma_f32 v62, v62, s48, -v97
  v_fma_f32 v63, v63, s48, -v97
  v_exp_f32 v60, v60
  v_exp_f32 v61, v61
  v_exp_f32 v62, v62
  v_exp_f32 v63, v63
  s_nop 0
  v_cvt_pk_bf16_f32 v80, v60, v61
  v_cvt_pk_bf16_f32 v81, v62, v63
  v_add_f32 v106, v60, v61
  v_add_f32 v107, v62, v63
  v_add_f32 v91, v91, v106
  v_add_f32 v91, v91, v107
  v_perm_b32 v82, v80, v80, v98
  v_perm_b32 v83, v80, v80, v99
  v_perm_b32 v84, v80, v80, v100
  v_perm_b32 v85, v80, v80, v101
  s_waitcnt lgkmcnt(3)
  s_nop 0
  v_mfma_f32_16x16x32_bf16 v[92:95], v[82:85], v[32:35], v[92:95]
  s_waitcnt vmcnt(4)
  buffer_load_dwordx4 v6, s[12:15], s45 offen offset:3072 nt lds
  v_perm_b32 v86, v80, v80, v102
  v_perm_b32 v87, v80, v80, v103
  v_perm_b32 v88, v80, v80, v104
  v_perm_b32 v89, v80, v80, v105
  s_waitcnt lgkmcnt(2)
  s_nop 0
  v_mfma_f32_16x16x32_bf16 v[92:95], v[86:89], v[36:39], v[92:95]
  s_add_u32 s45, s44, 98304
  s_add_u32 m0, s46, 24576
  s_waitcnt vmcnt(4)
  buffer_load_dwordx4 v6, s[12:15], s45 offen offset:0 nt lds
  v_perm_b32 v82, v81, v81, v98
  v_perm_b32 v83, v81, v81, v99
  v_perm_b32 v84, v81, v81, v100
  v_perm_b32 v85, v81, v81, v101
  s_waitcnt lgkmcnt(1)
  s_nop 0
  v_mfma_f32_16x16x32_bf16 v[92:95], v[82:85], v[40:43], v[92:95]
  s_waitcnt vmcnt(4)
  buffer_load_dwordx4 v6, s[12:15], s45 offen offset:1024 nt lds
  v_perm_b32 v86, v81, v81, v102
  v_perm_b32 v87, v81, v81, v103
  v_perm_b32 v88, v81, v81, v104
  v_perm_b32 v89, v81, v81, v105
  s_waitcnt lgkmcnt(0)
  s_nop 0
  v_mfma_f32_16x16x32_bf16 v[92:95], v[86:89], v[44:47], v[92:95]
  s_waitcnt vmcnt(4)
  buffer_load_dwordx4 v6, s[12:15], s45 offen offset:2048 nt lds
  ds_read_b128 v[32:35], v12 offset:16384
  ds_read_b128 v[36:39], v12 offset:16640
  ds_read_b128 v[40:43], v12 offset:16896
  ds_read_b128 v[44:47], v12 offset:17152
  v_fma_f32 v64, v64, s48, -v97
  v_fma_f32 v65, v65, s48, -v97
  v_fma_f32 v66, v66, s48, -v97
  v_fma_f32 v67, v67, s48, -v97
  v_exp_f32 v64, v64
  v_exp_f32 v65, v65
  v_exp_f32 v66, v66
  v_exp_f32 v67, v67
  s_nop 0
  v_cvt_pk_bf16_f32 v80, v64, v65
  v_cvt_pk_bf16_f32 v81, v66, v67
  v_add_f32 v106, v64, v65
  v_add_f32 v107, v66, v67
  v_add_f32 v91, v91, v106
  v_add_f32 v91, v91, v107
  v_perm_b32 v82, v80, v80, v98
  v_perm_b32 v83, v80, v80, v99
  v_perm_b32 v84, v80, v80, v100
  v_perm_b32 v85, v80, v80, v101
  s_waitcnt lgkmcnt(3)
  s_nop 0
  v_mfma_f32_16x16x32_bf16 v[92:95], v[82:85], v[32:35], v[92:95]
  s_waitcnt vmcnt(4)
  buffer_load_dwordx4 v6, s[12:15], s45 offen offset:3072 nt lds
  v_perm_b32 v86, v80, v80, v102
  v_perm_b32 v87, v80, v80, v103
  v_perm_b32 v88, v80, v80, v104
  v_perm_b32 v89, v80, v80, v105
  s_waitcnt lgkmcnt(2)
  s_nop 0
  v_mfma_f32_16x16x32_bf16 v[92:95], v[86:89], v[36:39], v[92:95]
  s_add_u32 s45, s44, 102400
  s_add_u32 m0, s46, 28672
  s_waitcnt vmcnt(4)
  buffer_load_dwordx4 v6, s[12:15], s45 offen offset:0 nt lds
  v_perm_b32 v82, v81, v81, v98
  v_perm_b32 v83, v81, v81, v99
  v_perm_b32 v84, v81, v81, v100
  v_perm_b32 v85, v81, v81, v101
  s_waitcnt lgkmcnt(1)
  s_nop 0
  v_mfma_f32_16x16x32_bf16 v[92:95], v[82:85], v[40:43], v[92:95]
  s_waitcnt vmcnt(4)
  buffer_load_dwordx4 v6, s[12:15], s45 offen offset:1024 nt lds
  v_perm_b32 v86, v81, v81, v102
  v_perm_b32 v87, v81, v81, v103
  v_perm_b32 v88, v81, v81, v104
  v_perm_b32 v89, v81, v81, v105
  s_waitcnt lgkmcnt(0)
  s_nop 0
  v_mfma_f32_16x16x32_bf16 v[92:95], v[86:89], v[44:47], v[92:95]
  s_waitcnt vmcnt(4)
  buffer_load_dwordx4 v6, s[12:15], s45 offen offset:2048 nt lds
  ds_read_b128 v[32:35], v12 offset:20480
  ds_read_b128 v[36:39], v12 offset:20736
  ds_read_b128 v[40:43], v12 offset:20992
  ds_read_b128 v[44:47], v12 offset:21248
  v_fma_f32 v68, v68, s48, -v97
  v_fma_f32 v69, v69, s48, -v97
  v_fma_f32 v70, v70, s48, -v97
  v_fma_f32 v71, v71, s48, -v97
  v_exp_f32 v68, v68
  v_exp_f32 v69, v69
  v_exp_f32 v70, v70
  v_exp_f32 v71, v71
  s_nop 0
  v_cvt_pk_bf16_f32 v80, v68, v69
  v_cvt_pk_bf16_f32 v81, v70, v71
  v_add_f32 v106, v68, v69
  v_add_f32 v107, v70, v71
  v_add_f32 v91, v91, v106
  v_add_f32 v91, v91, v107
  v_perm_b32 v82, v80, v80, v98
  v_perm_b32 v83, v80, v80, v99
  v_perm_b32 v84, v80, v80, v100
  v_perm_b32 v85, v80, v80, v101
  s_waitcnt lgkmcnt(3)
  s_nop 0
  v_mfma_f32_16x16x32_bf16 v[92:95], v[82:85], v[32:35], v[92:95]
  s_waitcnt vmcnt(4)
  buffer_load_dwordx4 v6, s[12:15], s45 offen offset:3072 nt lds
  s_add_u32 s44, s44, 131072
  v_perm_b32 v86, v80, v80, v102
  v_perm_b32 v87, v80, v80, v103
  v_perm_b32 v88, v80, v80, v104
  v_perm_b32 v89, v80, v80, v105
  s_waitcnt lgkmcnt(2)
  s_nop 0
  v_mfma_f32_16x16x32_bf16 v[92:95], v[86:89], v[36:39], v[92:95]
  s_add_u32 s45, s44, 0
  s_add_u32 m0, s46, 0
  s_waitcnt vmcnt(4)
  buffer_load_dwordx4 v2, s[8:11], s45 offen offset:0 nt lds
  v_perm_b32 v82, v81, v81, v98
  v_perm_b32 v83, v81, v81, v99
  v_perm_b32 v84, v81, v81, v100
  v_perm_b32 v85, v81, v81, v101
  s_waitcnt lgkmcnt(1)
  s_nop 0
  v_mfma_f32_16x16x32_bf16 v[92:95], v[82:85], v[40:43], v[92:95]
  s_waitcnt vmcnt(4)
  buffer_load_dwordx4 v3, s[8:11], s45 offen offset:1024 nt lds
  v_perm_b32 v86, v81, v81, v102
  v_perm_b32 v87, v81, v81, v103
  v_perm_b32 v88, v81, v81, v104
  v_perm_b32 v89, v81, v81, v105
  s_waitcnt lgkmcnt(0)
  s_nop 0
  v_mfma_f32_16x16x32_bf16 v[92:95], v[86:89], v[44:47], v[92:95]
  s_waitcnt vmcnt(4)
  buffer_load_dwordx4 v4, s[8:11], s45 offen offset:2048 nt lds
  ds_read_b128 v[32:35], v12 offset:24576
  ds_read_b128 v[36:39], v12 offset:24832
  ds_read_b128 v[40:43], v12 offset:25088
  ds_read_b128 v[44:47], v12 offset:25344
  v_fma_f32 v72, v72, s48, -v97
  v_fma_f32 v73, v73, s48, -v97
  v_fma_f32 v74, v74, s48, -v97
  v_fma_f32 v75, v75, s48, -v97
  v_exp_f32 v72, v72
  v_exp_f32 v73, v73
  v_exp_f32 v74, v74
  v_exp_f32 v75, v75
  s_nop 0
  v_cvt_pk_bf16_f32 v80, v72, v73
  v_cvt_pk_bf16_f32 v81, v74, v75
  v_add_f32 v106, v72, v73
  v_add_f32 v107, v74, v75
  v_add_f32 v91, v91, v106
  v_add_f32 v91, v91, v107
  v_perm_b32 v82, v80, v80, v98
  v_perm_b32 v83, v80, v80, v99
  v_perm_b32 v84, v80, v80, v100
  v_perm_b32 v85, v80, v80, v101
  s_waitcnt lgkmcnt(3)
  s_nop 0
  v_mfma_f32_16x16x32_bf16 v[92:95], v[82:85], v[32:35], v[92:95]
  s_waitcnt vmcnt(4)
  buffer_load_dwordx4 v5, s[8:11], s45 offen offset:3072 nt lds
  v_perm_b32 v86, v80, v80, v102
  v_perm_b32 v87, v80, v80, v103
  v_perm_b32 v88, v80, v80, v104
  v_perm_b32 v89, v80, v80, v105
  s_waitcnt lgkmcnt(2)
  s_nop 0
  v_mfma_f32_16x16x32_bf16 v[92:95], v[86:89], v[36:39], v[92:95]
  s_add_u32 s45, s44, 4096
  s_add_u32 m0, s46, 4096
  s_waitcnt vmcnt(4)
  buffer_load_dwordx4 v2, s[8:11], s45 offen offset:0 nt lds
  v_perm_b32 v82, v81, v81, v98
  v_perm_b32 v83, v81, v81, v99
  v_perm_b32 v84, v81, v81, v100
  v_perm_b32 v85, v81, v81, v101
  s_waitcnt lgkmcnt(1)
  s_nop 0
  v_mfma_f32_16x16x32_bf16 v[92:95], v[82:85], v[40:43], v[92:95]
  s_waitcnt vmcnt(4)
  buffer_load_dwordx4 v3, s[8:11], s45 offen offset:1024 nt lds
  v_perm_b32 v86, v81, v81, v102
  v_perm_b32 v87, v81, v81, v103
  v_perm_b32 v88, v81, v81, v104
  v_perm_b32 v89, v81, v81, v105
  s_waitcnt lgkmcnt(0)
  s_nop 0
  v_mfma_f32_16x16x32_bf16 v[92:95], v[86:89], v[44:47], v[92:95]
  s_waitcnt vmcnt(4)
  buffer_load_dwordx4 v4, s[8:11], s45 offen offset:2048 nt lds
  ds_read_b128 v[32:35], v12 offset:28672
  ds_read_b128 v[36:39], v12 offset:28928
  ds_read_b128 v[40:43], v12 offset:29184
  ds_read_b128 v[44:47], v12 offset:29440
  v_fma_f32 v76, v76, s48, -v97
  v_fma_f32 v77, v77, s48, -v97
  v_fma_f32 v78, v78, s48, -v97
  v_fma_f32 v79, v79, s48, -v97
  v_exp_f32 v76, v76
  v_exp_f32 v77, v77
  v_exp_f32 v78, v78
  v_exp_f32 v79, v79
  s_nop 0
  v_cvt_pk_bf16_f32 v80, v76, v77
  v_cvt_pk_bf16_f32 v81, v78, v79
  v_add_f32 v106, v76, v77
  v_add_f32 v107, v78, v79
  v_add_f32 v91, v91, v106
  v_add_f32 v91, v91, v107
  v_perm_b32 v82, v80, v80, v98
  v_perm_b32 v83, v80, v80, v99
  v_perm_b32 v84, v80, v80, v100
  v_perm_b32 v85, v80, v80, v101
  s_waitcnt lgkmcnt(3)
  s_nop 0
  v_mfma_f32_16x16x32_bf16 v[92:95], v[82:85], v[32:35], v[92:95]
  s_waitcnt vmcnt(4)
  buffer_load_dwordx4 v5, s[8:11], s45 offen offset:3072 nt lds
  v_perm_b32 v86, v80, v80, v102
  v_perm_b32 v87, v80, v80, v103
  v_perm_b32 v88, v80, v80, v104
  v_perm_b32 v89, v80, v80, v105
  s_waitcnt lgkmcnt(2)
  s_nop 0
  v_mfma_f32_16x16x32_bf16 v[92:95], v[86:89], v[36:39], v[92:95]
  s_add_u32 s45, s44, 32768
  s_add_u32 m0, s46, 8192
  s_waitcnt vmcnt(4)
  buffer_load_dwordx4 v2, s[8:11], s45 offen offset:0 nt lds
  v_perm_b32 v82, v81, v81, v98
  v_perm_b32 v83, v81, v81, v99
  v_perm_b32 v84, v81, v81, v100
  v_perm_b32 v85, v81, v81, v101
  s_waitcnt lgkmcnt(1)
  s_nop 0
  v_mfma_f32_16x16x32_bf16 v[92:95], v[82:85], v[40:43], v[92:95]
  s_waitcnt vmcnt(4)
  buffer_load_dwordx4 v3, s[8:11], s45 offen offset:1024 nt lds
  v_perm_b32 v86, v81, v81, v102
  v_perm_b32 v87, v81, v81, v103
  v_perm_b32 v88, v81, v81, v104
  v_perm_b32 v89, v81, v81, v105
  s_waitcnt lgkmcnt(0)
  s_nop 0
  v_mfma_f32_16x16x32_bf16 v[92:95], v[86:89], v[44:47], v[92:95]
L_snext:
  s_add_u32 s47, s47, 1
  s_cmp_le_u32 s47, 6
  s_cbranch_scc1 L_sloop
  v_mov_b32 v106, v91
  s_nop 1
  v_permlane16_swap_b32 v91, v106
  s_nop 1
  v_add_f32 v91, v91, v106
  v_mov_b32 v106, v91
  s_nop 1
  v_permlane32_swap_b32 v91, v106
  s_nop 1
  v_add_f32 v91, v91, v106
  v_and_b32 v106, 15, v0
  v_lshrrev_b32 v107, 4, v0
  v_lshlrev_b32 v106, 5, v106
  v_lshl_add_u32 v106, v107, 4, v106
  s_lshl_b32 s40, s3, 9
  s_add_u32 s40, s40, 138240
  v_add_u32 v106, s40, v106
  s_lshl_b32 s40, s3, 2
  s_add_u32 s40, s40, 140288
  v_mov_b32 v108, s40
  s_mov_b32 exec_hi, 0
  ds_write_b128 v106, v[92:95]
  s_mov_b64 exec, 1
  ds_write_b32 v108, v90
  ds_write_b32 v108, v91 offset:16
  s_mov_b64 exec, -1
  s_waitcnt lgkmcnt(0)
  s_barrier
  s_cmp_eq_u32 s39, s38
  s_cbranch_scc1 L_reducer
  s_branch L_tail
L_side:
  s_sub_u32 s62, s3, 4
  s_waitcnt lgkmcnt(0)
  v_mov_b32 v21, 150596
  v_mov_b32 v22, 0
  ds_write_b32 v21, v22
  ds_write_b32 v21, v22 offset:12
  s_mul_i32 s40, s38, 1152
  s_add_u32 s8, s16, s40
  s_addc_u32 s9, s17, 0
  s_mov_b32 s10, 1152
  s_mov_b32 s11, 0x20000
  v_lshlrev_b32 v17, 2, v0
  buffer_load_dword v12, v17, s[8:11], 0 offen offset:0
  buffer_load_dword v13, v17, s[8:11], 0 offen offset:256
  buffer_load_dword v14, v17, s[8:11], 0 offen offset:512
  buffer_load_dword v15, v17, s[8:11], 0 offen offset:768
  buffer_load_dword v16, v17, s[8:11], 0 offen offset:1024
  s_lshl_b32 s40, s39, 8
  s_sub_u32 s41, 4718592, s40
  s_add_u32 s12, s20, s40
  s_addc_u32 s13, s21, 0
  s_mov_b32 s14, s41
  s_mov_b32 s15, 0x20000
  s_mul_i32 s47, s38, 18
  s_lshr_b32 s47, s47, 3
  s_lshl_b32 s47, s47, 1
  v_lshrrev_b32 v18, 4, v0
  v_and_b32 v19, 15, v0
  v_mul_u32_u24 v20, 36, v18
  s_mul_i32 s42, s62, 144
  v_add_u32 v20, s42, v20
  v_lshlrev_b32 v90, 13, v20
  v_lshl_add_u32 v90, v19, 4, v90
  s_lshl_b32 s44, s47, 13
  buffer_load_dwordx4 v[96:99], v90, s[12:15], s44 offen
  s_add_u32 s44, s44, 8192
  s_cmp_ge_u32 s44, 294912
  s_cselect_b32 s44, 0, s44
  buffer_load_dwordx4 v[100:103], v90, s[12:15], s44 offen
  s_add_u32 s44, s44, 8192
  s_cmp_ge_u32 s44, 294912
  s_cselect_b32 s44, 0, s44
  buffer_load_dwordx4 v[104:107], v90, s[12:15], s44 offen
  s_add_u32 s44, s44, 8192
  s_cmp_ge_u32 s44, 294912
  s_cselect_b32 s44, 0, s44
  buffer_load_dwordx4 v[108:111], v90, s[12:15], s44 offen
  s_add_u32 s44, s44, 8192
  s_cmp_ge_u32 s44, 294912
  s_cselect_b32 s44, 0, s44
  s_waitcnt lgkmcnt(0)
  s_barrier
  s_mov_b32 s43, 9216
  v_mul_lo_u32 v91, v20, s43
  v_lshl_add_u32 v91, v19, 4, v91
  v_add_u32 v92, 256, v91
  v_mov_b32 v21, 0x7f000000
  v_cmp_gt_u32 vcc, 2, v19
  s_nop 1
  v_cndmask_b32 v92, v21, v92, vcc
  v_and_b32 v21, 15, v0
  v_and_b32 v22, 1, v21
  v_mov_b32 v23, 0x0c0c0100
  v_mov_b32 v24, 0x01000c0c
  v_cmp_eq_u32 vcc, 1, v22
  s_nop 1
  v_cndmask_b32 v23, v23, v24, vcc
  v_mov_b32 v24, 0x0c0c0302
  v_mov_b32 v22, 0x03020c0c
  v_cndmask_b32 v24, v24, v22, vcc
  v_lshrrev_b32 v21, 1, v21
  v_mov_b32 v22, 0x0c0c0c0c
  v_cmp_eq_u32 vcc, 0, v21
  s_nop 1
  v_cndmask_b32 v28, v22, v23, vcc
  v_cndmask_b32 v32, v22, v24, vcc
  v_cmp_eq_u32 vcc, 1, v21
  s_nop 1
  v_cndmask_b32 v29, v22, v23, vcc
  v_cndmask_b32 v33, v22, v24, vcc
  v_cmp_eq_u32 vcc, 2, v21
  s_nop 1
  v_cndmask_b32 v30, v22, v23, vcc
  v_cndmask_b32 v34, v22, v24, vcc
  v_cmp_eq_u32 vcc, 3, v21
  s_nop 1
  v_cndmask_b32 v31, v22, v23, vcc
  v_cndmask_b32 v35, v22, v24, vcc
  s_mov_b32 s80, 0xffff0000
  s_mul_i32 s40, s62, 2560
  s_add_u32 s40, s40, 140352
  s_movk_i32 s41, 3641
  v_add_u32 v21, 0, v0
  v_mul_u32_u24 v22, s41, v21
  v_lshrrev_b32 v22, 16, v22
  v_mul_u32_u24 v22, 72, v22
  v_lshl_add_u32 v44, v21, 2, v22
  v_add_u32 v44, s40, v44
  v_add_u32 v21, 64, v0
  v_mul_u32_u24 v22, s41, v21
  v_lshrrev_b32 v22, 16, v22
  v_mul_u32_u24 v22, 72, v22
  v_lshl_add_u32 v45, v21, 2, v22
  v_add_u32 v45, s40, v45
  v_add_u32 v21, 128, v0
  v_mul_u32_u24 v22, s41, v21
  v_lshrrev_b32 v22, 16, v22
  v_mul_u32_u24 v22, 72, v22
  v_lshl_add_u32 v46, v21, 2, v22
  v_add_u32 v46, s40, v46
  v_add_u32 v21, 192, v0
  v_mul_u32_u24 v22, s41, v21
  v_lshrrev_b32 v22, 16, v22
  v_mul_u32_u24 v22, 72, v22
  v_lshl_add_u32 v47, v21, 2, v22
  v_add_u32 v47, s40, v47
  v_add_u32 v21, 256, v0
  v_mul_u32_u24 v22, s41, v21
  v_lshrrev_b32 v22, 16, v22
  v_mul_u32_u24 v22, 72, v22
  v_lshl_add_u32 v48, v21, 2, v22
  v_add_u32 v48, s40, v48
  s_mul_i32 s41, s62, 576
  s_add_u32 s40, s40, s41
  s_lshl_b32 s41, s47, 1
  s_add_u32 s40, s40, s41
  v_mul_u32_u24 v94, 144, v18
  v_add_u32 v94, s40, v94
  s_mov_b32 s60, -1
  s_mov_b32 s61, 0
  v_mov_b32 v21, 150596
  v_mov_b32 v22, 0
  ds_write_b32 v21, v22 offset:4
  v_mov_b32 v22, 5
  ds_write_b32 v21, v22 offset:8
  s_waitcnt vmcnt(4)
  v_lshlrev_b32 v2, 16, v12
  v_and_b32 v3, s80, v12
  v_lshlrev_b32 v4, 16, v13
  v_and_b32 v5, s80, v13
  v_lshlrev_b32 v6, 16, v14
  v_and_b32 v7, s80, v14
  v_lshlrev_b32 v8, 16, v15
  v_and_b32 v9, s80, v15
  v_lshlrev_b32 v10, 16, v16
  v_and_b32 v11, s80, v16
  v_add_f32 v25, v2, v3
  v_add_f32 v25, v25, v4
  v_add_f32 v25, v25, v5
  v_add_f32 v25, v25, v6
  v_add_f32 v25, v25, v7
  v_add_f32 v25, v25, v8
  v_add_f32 v25, v25, v9
  v_add_f32 v25, v25, v10
  v_add_f32 v25, v25, v11
  s_nop 1
  v_add_f32_dpp v25, v25, v25 row_ror:8 row_mask:0xf bank_mask:0xf
  s_nop 1
  v_add_f32_dpp v25, v25, v25 row_ror:4 row_mask:0xf bank_mask:0xf
  s_nop 1
  v_add_f32_dpp v25, v25, v25 row_ror:2 row_mask:0xf bank_mask:0xf
  s_nop 1
  v_add_f32_dpp v25, v25, v25 row_ror:1 row_mask:0xf bank_mask:0xf
  v_mov_b32 v26, v25
  s_nop 1
  v_permlane16_swap_b32 v25, v26
  s_nop 1
  v_add_f32 v25, v25, v26
  v_mov_b32 v26, v25
  s_nop 1
  v_permlane32_swap_b32 v25, v26
  s_nop 1
  v_add_f32 v25, v25, v26
  v_mul_f32 v25, 0x3ae38e39, v25
  v_sub_f32 v26, v2, v25
  v_mul_f32 v27, v26, v26
  v_sub_f32 v26, v3, v25
  v_fmac_f32 v27, v26, v26
  v_sub_f32 v26, v4, v25
  v_fmac_f32 v27, v26, v26
  v_sub_f32 v26, v5, v25
  v_fmac_f32 v27, v26, v26
  v_sub_f32 v26, v6, v25
  v_fmac_f32 v27, v26, v26
  v_sub_f32 v26, v7, v25
  v_fmac_f32 v27, v26, v26
  v_sub_f32 v26, v8, v25
  v_fmac_f32 v27, v26, v26
  v_sub_f32 v26, v9, v25
  v_fmac_f32 v27, v26, v26
  v_sub_f32 v26, v10, v25
  v_cndmask_b32 v26, 0, v26, s[60:61]
  v_fmac_f32 v27, v26, v26
  v_sub_f32 v26, v11, v25
  v_cndmask_b32 v26, 0, v26, s[60:61]
  v_fmac_f32 v27, v26, v26
  s_nop 1
  v_add_f32_dpp v27, v27, v27 row_ror:8 row_mask:0xf bank_mask:0xf
  s_nop 1
  v_add_f32_dpp v27, v27, v27 row_ror:4 row_mask:0xf bank_mask:0xf
  s_nop 1
  v_add_f32_dpp v27, v27, v27 row_ror:2 row_mask:0xf bank_mask:0xf
  s_nop 1
  v_add_f32_dpp v27, v27, v27 row_ror:1 row_mask:0xf bank_mask:0xf
  v_mov_b32 v26, v27
  s_nop 1
  v_permlane16_swap_b32 v27, v26
  s_nop 1
  v_add_f32 v27, v27, v26
  v_mov_b32 v26, v27
  s_nop 1
  v_permlane32_swap_b32 v27, v26
  s_nop 1
  v_add_f32 v27, v27, v26
  v_mul_f32 v27, 0x3ae38e39, v27
  v_cvt_pk_bf16_f32 v26, v25, v27
  v_lshlrev_b32 v25, 16, v26
  v_and_b32 v27, s80, v26
  v_add_f32 v27, 0x3727c5ac, v27
  v_cvt_pk_bf16_f32 v27, v27, v27
  v_and_b32 v27, s80, v27
  v_sqrt_f32 v27, v27
  s_nop 0
  v_cvt_pk_bf16_f32 v27, v27, v27
  v_and_b32 v27, s80, v27
  v_rcp_f32 v27, v27
  v_sub_f32 v2, v2, v25
  v_sub_f32 v3, v3, v25
  v_cvt_pk_bf16_f32 v26, v2, v3
  v_lshlrev_b32 v2, 16, v26
  v_and_b32 v3, s80, v26
  v_mul_f32 v2, v2, v27
  v_mul_f32 v3, v3, v27
  v_cvt_pk_bf16_f32 v12, v2, v3
  v_lshlrev_b32 v2, 16, v12
  v_and_b32 v3, s80, v12
  ds_write_b32 v44, v12
  ds_write_b32 v44, v12 offset:72
  v_sub_f32 v4, v4, v25
  v_sub_f32 v5, v5, v25
  v_cvt_pk_bf16_f32 v26, v4, v5
  v_lshlrev_b32 v4, 16, v26
  v_and_b32 v5, s80, v26
  v_mul_f32 v4, v4, v27
  v_mul_f32 v5, v5, v27
  v_cvt_pk_bf16_f32 v13, v4, v5
  v_lshlrev_b32 v4, 16, v13
  v_and_b32 v5, s80, v13
  ds_write_b32 v45, v13
  ds_write_b32 v45, v13 offset:72
  v_sub_f32 v6, v6, v25
  v_sub_f32 v7, v7, v25
  v_cvt_pk_bf16_f32 v26, v6, v7
  v_lshlrev_b32 v6, 16, v26
  v_and_b32 v7, s80, v26
  v_mul_f32 v6, v6, v27
  v_mul_f32 v7, v7, v27
  v_cvt_pk_bf16_f32 v14, v6, v7
  v_lshlrev_b32 v6, 16, v14
  v_and_b32 v7, s80, v14
  ds_write_b32 v46, v14
  ds_write_b32 v46, v14 offset:72
  v_sub_f32 v8, v8, v25
  v_sub_f32 v9, v9, v25
  v_cvt_pk_bf16_f32 v26, v8, v9
  v_lshlrev_b32 v8, 16, v26
  v_and_b32 v9, s80, v26
  v_mul_f32 v8, v8, v27
  v_mul_f32 v9, v9, v27
  v_cvt_pk_bf16_f32 v15, v8, v9
  v_lshlrev_b32 v8, 16, v15
  v_and_b32 v9, s80, v15
  ds_write_b32 v47, v15
  ds_write_b32 v47, v15 offset:72
  v_sub_f32 v10, v10, v25
  v_sub_f32 v11, v11, v25
  v_cvt_pk_bf16_f32 v26, v10, v11
  v_lshlrev_b32 v10, 16, v26
  v_and_b32 v11, s80, v26
  v_mul_f32 v10, v10, v27
  v_mul_f32 v11, v11, v27
  v_cvt_pk_bf16_f32 v16, v10, v11
  v_lshlrev_b32 v10, 16, v16
  v_and_b32 v11, s80, v16
  s_mov_b32 exec_hi, 0
  ds_write_b32 v48, v16
  ds_write_b32 v48, v16 offset:72
  s_mov_b64 exec, -1
  v_cndmask_b32 v10, 0, v10, s[60:61]
  v_cndmask_b32 v11, 0, v11, s[60:61]
  s_waitcnt lgkmcnt(0)
  ds_read2_b32 v[72:73], v94 offset0:0 offset1:1
  ds_read2_b32 v[74:75], v94 offset0:2 offset1:3
  ds_read2_b32 v[76:77], v94 offset0:4 offset1:5
  ds_read2_b32 v[78:79], v94 offset0:6 offset1:7
  ds_read2_b32 v[80:81], v94 offset0:8 offset1:9
  ds_read2_b32 v[82:83], v94 offset0:10 offset1:11
  ds_read2_b32 v[84:85], v94 offset0:12 offset1:13
  ds_read2_b32 v[86:87], v94 offset0:14 offset1:15
  ds_read2_b32 v[88:89], v94 offset0:16 offset1:17
  s_waitcnt lgkmcnt(0)
  v_perm_b32 v36, v72, v72, v28
  v_perm_b32 v37, v72, v72, v29
  v_perm_b32 v38, v72, v72, v30
  v_perm_b32 v39, v72, v72, v31
  s_waitcnt vmcnt(3)
  s_nop 0
  v_mfma_f32_16x16x32_bf16 v[64:67], v[36:39], v[96:99], 0
  buffer_load_dwordx4 v[112:115], v90, s[12:15], s44 offen
  s_add_u32 s44, s44, 8192
  s_cmp_ge_u32 s44, 294912
  s_cselect_b32 s44, 0, s44
  v_perm_b32 v40, v72, v72, v32
  v_perm_b32 v41, v72, v72, v33
  v_perm_b32 v42, v72, v72, v34
  v_perm_b32 v43, v72, v72, v35
  s_waitcnt vmcnt(3)
  s_nop 0
  v_mfma_f32_16x16x32_bf16 v[64:67], v[40:43], v[100:103], v[64:67]
  buffer_load_dwordx4 v[116:119], v90, s[12:15], s44 offen
  s_add_u32 s44, s44, 8192
  s_cmp_ge_u32 s44, 294912
  s_cselect_b32 s44, 0, s44
  v_perm_b32 v36, v73, v73, v28
  v_perm_b32 v37, v73, v73, v29
  v_perm_b32 v38, v73, v73, v30
  v_perm_b32 v39, v73, v73, v31
  s_waitcnt vmcnt(3)
  s_nop 0
  v_mfma_f32_16x16x32_bf16 v[64:67], v[36:39], v[104:107], v[64:67]
  buffer_load_dwordx4 v[120:123], v90, s[12:15], s44 offen
  s_add_u32 s44, s44, 8192
  s_cmp_ge_u32 s44, 294912
  s_cselect_b32 s44, 0, s44
  v_perm_b32 v40, v73, v73, v32
  v_perm_b32 v41, v73, v73, v33
  v_perm_b32 v42, v73, v73, v34
  v_perm_b32 v43, v73, v73, v35
  s_waitcnt vmcnt(3)
  s_nop 0
  v_mfma_f32_16x16x32_bf16 v[64:67], v[40:43], v[108:111], v[64:67]
  buffer_load_dwordx4 v[124:127], v90, s[12:15], s44 offen
  s_add_u32 s44, s44, 8192
  s_cmp_ge_u32 s44, 294912
  s_cselect_b32 s44, 0, s44
  v_perm_b32 v36, v74, v74, v28
  v_perm_b32 v37, v74, v74, v29
  v_perm_b32 v38, v74, v74, v30
  v_perm_b32 v39, v74, v74, v31
  s_waitcnt vmcnt(3)
  s_nop 0
  v_mfma_f32_16x16x32_bf16 v[64:67], v[36:39], v[112:115], v[64:67]
  buffer_load_dwordx4 v[128:131], v90, s[12:15], s44 offen
  s_add_u32 s44, s44, 8192
  s_cmp_ge_u32 s44, 294912
  s_cselect_b32 s44, 0, s44
  v_perm_b32 v40, v74, v74, v32
  v_perm_b32 v41, v74, v74, v33
  v_perm_b32 v42, v74, v74, v34
  v_perm_b32 v43, v74, v74, v35
  s_waitcnt vmcnt(3)
  s_nop 0
  v_mfma_f32_16x16x32_bf16 v[64:67], v[40:43], v[116:119], v[64:67]
  buffer_load_dwordx4 v[132:135], v90, s[12:15], s44 offen
  s_add_u32 s44, s44, 8192
  s_cmp_ge_u32 s44, 294912
  s_cselect_b32 s44, 0, s44
  v_perm_b32 v36, v75, v75, v28
  v_perm_b32 v37, v75, v75, v29
  v_perm_b32 v38, v75, v75, v30
  v_perm_b32 v39, v75, v75, v31
  s_waitcnt vmcnt(3)
  s_nop 0
  v_mfma_f32_16x16x32_bf16 v[64:67], v[36:39], v[120:123], v[64:67]
  buffer_load_dwordx4 v[136:139], v90, s[12:15], s44 offen
  s_add_u32 s44, s44, 8192
  s_cmp_ge_u32 s44, 294912
  s_cselect_b32 s44, 0, s44
  v_perm_b32 v40, v75, v75, v32
  v_perm_b32 v41, v75, v75, v33
  v_perm_b32 v42, v75, v75, v34
  v_perm_b32 v43, v75, v75, v35
  s_waitcnt vmcnt(3)
  s_nop 0
  v_mfma_f32_16x16x32_bf16 v[64:67], v[40:43], v[124:127], v[64:67]
  buffer_load_dwordx4 v[140:143], v90, s[12:15], s44 offen
  s_add_u32 s44, s44, 8192
  s_cmp_ge_u32 s44, 294912
  s_cselect_b32 s44, 0, s44
  v_perm_b32 v36, v76, v76, v28
  v_perm_b32 v37, v76, v76, v29
  v_perm_b32 v38, v76, v76, v30
  v_perm_b32 v39, v76, v76, v31
  s_waitcnt vmcnt(3)
  s_nop 0
  v_mfma_f32_16x16x32_bf16 v[64:67], v[36:39], v[128:131], v[64:67]
  buffer_load_dwordx4 v[144:147], v90, s[12:15], s44 offen
  s_add_u32 s44, s44, 8192
  s_cmp_ge_u32 s44, 294912
  s_cselect_b32 s44, 0, s44
  v_perm_b32 v40, v76, v76, v32
  v_perm_b32 v41, v76, v76, v33
  v_perm_b32 v42, v76, v76, v34
  v_perm_b32 v43, v76, v76, v35
  s_waitcnt vmcnt(3)
  s_nop 0
  v_mfma_f32_16x16x32_bf16 v[64:67], v[40:43], v[132:135], v[64:67]
  buffer_load_dwordx4 v[148:151], v90, s[12:15], s44 offen
  s_add_u32 s44, s44, 8192
  s_cmp_ge_u32 s44, 294912
  s_cselect_b32 s44, 0, s44
  v_perm_b32 v36, v77, v77, v28
  v_perm_b32 v37, v77, v77, v29
  v_perm_b32 v38, v77, v77, v30
  v_perm_b32 v39, v77, v77, v31
  s_waitcnt vmcnt(3)
  s_nop 0
  v_mfma_f32_16x16x32_bf16 v[64:67], v[36:39], v[136:139], v[64:67]
  buffer_load_dwordx4 v[152:155], v90, s[12:15], s44 offen
  s_add_u32 s44, s44, 8192
  s_cmp_ge_u32 s44, 294912
  s_cselect_b32 s44, 0, s44
  v_perm_b32 v40, v77, v77, v32
  v_perm_b32 v41, v77, v77, v33
  v_perm_b32 v42, v77, v77, v34
  v_perm_b32 v43, v77, v77, v35
  s_waitcnt vmcnt(3)
  s_nop 0
  v_mfma_f32_16x16x32_bf16 v[64:67], v[40:43], v[140:143], v[64:67]
  buffer_load_dwordx4 v[156:159], v90, s[12:15], s44 offen
  s_add_u32 s44, s44, 8192
  s_cmp_ge_u32 s44, 294912
  s_cselect_b32 s44, 0, s44
  v_perm_b32 v36, v78, v78, v28
  v_perm_b32 v37, v78, v78, v29
  v_perm_b32 v38, v78, v78, v30
  v_perm_b32 v39, v78, v78, v31
  s_waitcnt vmcnt(3)
  s_nop 0
  v_mfma_f32_16x16x32_bf16 v[64:67], v[36:39], v[144:147], v[64:67]
  buffer_load_dwordx4 v[160:163], v90, s[12:15], s44 offen
  s_add_u32 s44, s44, 8192
  s_cmp_ge_u32 s44, 294912
  s_cselect_b32 s44, 0, s44
  v_perm_b32 v40, v78, v78, v32
  v_perm_b32 v41, v78, v78, v33
  v_perm_b32 v42, v78, v78, v34
  v_perm_b32 v43, v78, v78, v35
  s_waitcnt vmcnt(3)
  s_nop 0
  v_mfma_f32_16x16x32_bf16 v[64:67], v[40:43], v[148:151], v[64:67]
  buffer_load_dwordx4 v[164:167], v90, s[12:15], s44 offen
  s_add_u32 s44, s44, 8192
  s_cmp_ge_u32 s44, 294912
  s_cselect_b32 s44, 0, s44
  v_perm_b32 v36, v79, v79, v28
  v_perm_b32 v37, v79, v79, v29
  v_perm_b32 v38, v79, v79, v30
  v_perm_b32 v39, v79, v79, v31
  s_waitcnt vmcnt(3)
  s_nop 0
  v_mfma_f32_16x16x32_bf16 v[64:67], v[36:39], v[152:155], v[64:67]
  buffer_load_dwordx4 v[168:171], v90, s[12:15], s44 offen
  s_add_u32 s44, s44, 8192
  s_cmp_ge_u32 s44, 294912
  s_cselect_b32 s44, 0, s44
  v_perm_b32 v40, v79, v79, v32
  v_perm_b32 v41, v79, v79, v33
  v_perm_b32 v42, v79, v79, v34
  v_perm_b32 v43, v79, v79, v35
  s_waitcnt vmcnt(3)
  s_nop 0
  v_mfma_f32_16x16x32_bf16 v[64:67], v[40:43], v[156:159], v[64:67]
  buffer_load_dwordx4 v[172:175], v90, s[12:15], s44 offen
  s_add_u32 s44, s44, 8192
  s_cmp_ge_u32 s44, 294912
  s_cselect_b32 s44, 0, s44
  v_perm_b32 v36, v80, v80, v28
  v_perm_b32 v37, v80, v80, v29
  v_perm_b32 v38, v80, v80, v30
  v_perm_b32 v39, v80, v80, v31
  s_waitcnt vmcnt(3)
  s_nop 0
  v_mfma_f32_16x16x32_bf16 v[64:67], v[36:39], v[160:163], v[64:67]
  buffer_load_dwordx4 v[176:179], v90, s[12:15], s44 offen
  s_add_u32 s44, s44, 8192
  s_cmp_ge_u32 s44, 294912
  s_cselect_b32 s44, 0, s44
  v_perm_b32 v40, v80, v80, v32
  v_perm_b32 v41, v80, v80, v33
  v_perm_b32 v42, v80, v80, v34
  v_perm_b32 v43, v80, v80, v35
  s_waitcnt vmcnt(3)
  s_nop 0
  v_mfma_f32_16x16x32_bf16 v[64:67], v[40:43], v[164:167], v[64:67]
  buffer_load_dwordx4 v[180:183], v90, s[12:15], s44 offen
  s_add_u32 s44, s44, 8192
  s_cmp_ge_u32 s44, 294912
  s_cselect_b32 s44, 0, s44
  v_perm_b32 v36, v81, v81, v28
  v_perm_b32 v37, v81, v81, v29
  v_perm_b32 v38, v81, v81, v30
  v_perm_b32 v39, v81, v81, v31
  s_waitcnt vmcnt(3)
  s_nop 0
  v_mfma_f32_16x16x32_bf16 v[64:67], v[36:39], v[168:171], v[64:67]
  buffer_load_dwordx4 v[184:187], v90, s[12:15], s44 offen
  s_add_u32 s44, s44, 8192
  s_cmp_ge_u32 s44, 294912
  s_cselect_b32 s44, 0, s44
  v_perm_b32 v40, v81, v81, v32
  v_perm_b32 v41, v81, v81, v33
  v_perm_b32 v42, v81, v81, v34
  v_perm_b32 v43, v81, v81, v35
  s_waitcnt vmcnt(3)
  s_nop 0
  v_mfma_f32_16x16x32_bf16 v[64:67], v[40:43], v[172:175], v[64:67]
  buffer_load_dwordx4 v[188:191], v90, s[12:15], s44 offen
  s_add_u32 s44, s44, 8192
  s_cmp_ge_u32 s44, 294912
  s_cselect_b32 s44, 0, s44
  v_perm_b32 v36, v82, v82, v28
  v_perm_b32 v37, v82, v82, v29
  v_perm_b32 v38, v82, v82, v30
  v_perm_b32 v39, v82, v82, v31
  s_waitcnt vmcnt(3)
  s_nop 0
  v_mfma_f32_16x16x32_bf16 v[64:67], v[36:39], v[176:179], v[64:67]
  buffer_load_dwordx4 v[192:195], v90, s[12:15], s44 offen
  s_add_u32 s44, s44, 8192
  s_cmp_ge_u32 s44, 294912
  s_cselect_b32 s44, 0, s44
  v_perm_b32 v40, v82, v82, v32
  v_perm_b32 v41, v82, v82, v33
  v_perm_b32 v42, v82, v82, v34
  v_perm_b32 v43, v82, v82, v35
  s_waitcnt vmcnt(3)
  s_nop 0
  v_mfma_f32_16x16x32_bf16 v[64:67], v[40:43], v[180:183], v[64:67]
  buffer_load_dwordx4 v[196:199], v90, s[12:15], s44 offen
  s_add_u32 s44, s44, 8192
  s_cmp_ge_u32 s44, 294912
  s_cselect_b32 s44, 0, s44
  v_perm_b32 v36, v83, v83, v28
  v_perm_b32 v37, v83, v83, v29
  v_perm_b32 v38, v83, v83, v30
  v_perm_b32 v39, v83, v83, v31
  s_waitcnt vmcnt(3)
  s_nop 0
  v_mfma_f32_16x16x32_bf16 v[64:67], v[36:39], v[184:187], v[64:67]
  buffer_load_dwordx4 v[200:203], v90, s[12:15], s44 offen
  s_add_u32 s44, s44, 8192
  s_cmp_ge_u32 s44, 294912
  s_cselect_b32 s44, 0, s44
  v_perm_b32 v40, v83, v83, v32
  v_perm_b32 v41, v83, v83, v33
  v_perm_b32 v42, v83, v83, v34
  v_perm_b32 v43, v83, v83, v35
  s_waitcnt vmcnt(3)
  s_nop 0
  v_mfma_f32_16x16x32_bf16 v[64:67], v[40:43], v[188:191], v[64:67]
  buffer_load_dwordx4 v[204:207], v90, s[12:15], s44 offen
  s_add_u32 s44, s44, 8192
  s_cmp_ge_u32 s44, 294912
  s_cselect_b32 s44, 0, s44
  v_perm_b32 v36, v84, v84, v28
  v_perm_b32 v37, v84, v84, v29
  v_perm_b32 v38, v84, v84, v30
  v_perm_b32 v39, v84, v84, v31
  s_waitcnt vmcnt(3)
  s_nop 0
  v_mfma_f32_16x16x32_bf16 v[64:67], v[36:39], v[192:195], v[64:67]
  buffer_load_dwordx4 v[208:211], v90, s[12:15], s44 offen
  s_add_u32 s44, s44, 8192
  s_cmp_ge_u32 s44, 294912
  s_cselect_b32 s44, 0, s44
  v_perm_b32 v40, v84, v84, v32
  v_perm_b32 v41, v84, v84, v33
  v_perm_b32 v42, v84, v84, v34
  v_perm_b32 v43, v84, v84, v35
  s_waitcnt vmcnt(3)
  s_nop 0
  v_mfma_f32_16x16x32_bf16 v[64:67], v[40:43], v[196:199], v[64:67]
  buffer_load_dwordx4 v[212:215], v90, s[12:15], s44 offen
  s_add_u32 s44, s44, 8192
  s_cmp_ge_u32 s44, 294912
  s_cselect_b32 s44, 0, s44
  v_perm_b32 v36, v85, v85, v28
  v_perm_b32 v37, v85, v85, v29
  v_perm_b32 v38, v85, v85, v30
  v_perm_b32 v39, v85, v85, v31
  s_waitcnt vmcnt(3)
  s_nop 0
  v_mfma_f32_16x16x32_bf16 v[64:67], v[36:39], v[200:203], v[64:67]
  buffer_load_dwordx4 v[216:219], v90, s[12:15], s44 offen
  s_add_u32 s44, s44, 8192
  s_cmp_ge_u32 s44, 294912
  s_cselect_b32 s44, 0, s44
  v_perm_b32 v40, v85, v85, v32
  v_perm_b32 v41, v85, v85, v33
  v_perm_b32 v42, v85, v85, v34
  v_perm_b32 v43, v85, v85, v35
  s_waitcnt vmcnt(3)
  s_nop 0
  v_mfma_f32_16x16x32_bf16 v[64:67], v[40:43], v[204:207], v[64:67]
  buffer_load_dwordx4 v[220:223], v90, s[12:15], s44 offen
  s_add_u32 s44, s44, 8192
  s_cmp_ge_u32 s44, 294912
  s_cselect_b32 s44, 0, s44
  v_perm_b32 v36, v86, v86, v28
  v_perm_b32 v37, v86, v86, v29
  v_perm_b32 v38, v86, v86, v30
  v_perm_b32 v39, v86, v86, v31
  s_waitcnt vmcnt(3)
  s_nop 0
  v_mfma_f32_16x16x32_bf16 v[64:67], v[36:39], v[208:211], v[64:67]
  buffer_load_dwordx4 v[224:227], v90, s[12:15], s44 offen
  s_add_u32 s44, s44, 8192
  s_cmp_ge_u32 s44, 294912
  s_cselect_b32 s44, 0, s44
  v_perm_b32 v40, v86, v86, v32
  v_perm_b32 v41, v86, v86, v33
  v_perm_b32 v42, v86, v86, v34
  v_perm_b32 v43, v86, v86, v35
  s_waitcnt vmcnt(3)
  s_nop 0
  v_mfma_f32_16x16x32_bf16 v[64:67], v[40:43], v[212:215], v[64:67]
  buffer_load_dwordx4 v[228:231], v90, s[12:15], s44 offen
  s_add_u32 s44, s44, 8192
  s_cmp_ge_u32 s44, 294912
  s_cselect_b32 s44, 0, s44
  v_perm_b32 v36, v87, v87, v28
  v_perm_b32 v37, v87, v87, v29
  v_perm_b32 v38, v87, v87, v30
  v_perm_b32 v39, v87, v87, v31
  s_waitcnt vmcnt(3)
  s_nop 0
  v_mfma_f32_16x16x32_bf16 v[64:67], v[36:39], v[216:219], v[64:67]
  buffer_load_dwordx4 v[232:235], v90, s[12:15], s44 offen
  s_add_u32 s44, s44, 8192
  s_cmp_ge_u32 s44, 294912
  s_cselect_b32 s44, 0, s44
  v_perm_b32 v40, v87, v87, v32
  v_perm_b32 v41, v87, v87, v33
  v_perm_b32 v42, v87, v87, v34
  v_perm_b32 v43, v87, v87, v35
  s_waitcnt vmcnt(3)
  s_nop 0
  v_mfma_f32_16x16x32_bf16 v[64:67], v[40:43], v[220:223], v[64:67]
  buffer_load_dwordx4 v[236:239], v90, s[12:15], s44 offen
  v_perm_b32 v36, v88, v88, v28
  v_perm_b32 v37, v88, v88, v29
  v_perm_b32 v38, v88, v88, v30
  v_perm_b32 v39, v88, v88, v31
  s_waitcnt vmcnt(3)
  s_nop 0
  v_mfma_f32_16x16x32_bf16 v[64:67], v[36:39], v[224:227], v[64:67]
  v_perm_b32 v40, v88, v88, v32
  v_perm_b32 v41, v88, v88, v33
  v_perm_b32 v42, v88, v88, v34
  v_perm_b32 v43, v88, v88, v35
  s_waitcnt vmcnt(2)
  s_nop 0
  v_mfma_f32_16x16x32_bf16 v[64:67], v[40:43], v[228:231], v[64:67]
  v_perm_b32 v36, v89, v89, v28
  v_perm_b32 v37, v89, v89, v29
  v_perm_b32 v38, v89, v89, v30
  v_perm_b32 v39, v89, v89, v31
  s_waitcnt vmcnt(1)
  s_nop 0
  v_mfma_f32_16x16x32_bf16 v[64:67], v[36:39], v[232:235], v[64:67]
  v_perm_b32 v40, v89, v89, v32
  v_perm_b32 v41, v89, v89, v33
  v_perm_b32 v42, v89, v89, v34
  v_perm_b32 v43, v89, v89, v35
  s_waitcnt vmcnt(0)
  s_nop 0
  v_mfma_f32_16x16x32_bf16 v[64:67], v[40:43], v[236:239], v[64:67]
  v_and_b32 v17, 15, v0
  v_lshrrev_b32 v18, 4, v0
  v_lshlrev_b32 v17, 5, v17
  v_lshl_add_u32 v95, v18, 4, v17
  s_lshl_b32 s40, s62, 9
  s_add_u32 s40, s40, 131072
  v_add_u32 v17, s40, v95
  s_nop 4
  s_mov_b32 exec_hi, 0
  ds_write_b128 v17, v[64:67]
  s_mov_b64 exec, -1
  s_waitcnt lgkmcnt(0)
  v_mov_b32 v17, 150608
  v_mov_b32 v18, 1
  s_mov_b64 exec, 1
  ds_add_u32 v17, v18
  s_mov_b64 exec, -1
  s_cmp_lg_u32 s62, 0
  s_cbranch_scc1 L_noreset
  s_mul_i32 s40, s2, 2304
  s_add_u32 s52, s36, s40
  s_addc_u32 s53, s37, 0
  s_mov_b32 s54, 2304
  s_mov_b32 s55, 0x20000
  v_lshlrev_b32 v17, 4, v0
  s_cmp_eq_u32 s39, s38
  s_cselect_b32 s41, 0, -1
  v_mov_b32 v96, s41
  v_mov_b32 v97, s41
  v_mov_b32 v98, s41
  v_mov_b32 v99, s41
  buffer_store_dwordx4 v[96:99], v17, s[52:55], 0 offen offset:0 sc1
  buffer_store_dwordx4 v[96:99], v17, s[52:55], 0 offen offset:1024 sc1
  buffer_store_dwordx4 v[96:99], v17, s[52:55], 0 offen offset:2048 sc1
  s_waitcnt vmcnt(0)
  s_lshl_b32 s40, s38, 5
  v_mov_b32 v17, s40
  v_mov_b32 v18, 1
  s_mov_b64 exec, 1
  global_atomic_add v17, v18, s[34:35] offset:4
  s_mov_b64 exec, -1
  s_waitcnt vmcnt(0)
L_noreset:
  s_and_b32 s63, s39, 7
  s_lshl_b32 s63, s63, 2
  s_lshr_b32 s40, s39, 3
  s_add_u32 s63, s63, s40
  s_mul_i32 s40, s63, 288
  s_sub_u32 s41, 5308416, s40
  s_add_u32 s12, s24, s40
  s_addc_u32 s13, s25, 0
  s_mov_b32 s14, s41
  s_mov_b32 s15, 0x20000
  v_add_f32 v25, v2, v3
  v_add_f32 v25, v25, v4
  v_add_f32 v25, v25, v5
  v_add_f32 v25, v25, v6
  v_add_f32 v25, v25, v7
  v_add_f32 v25, v25, v8
  v_add_f32 v25, v25, v9
  v_add_f32 v25, v25, v10
  v_add_f32 v25, v25, v11
  s_nop 1
  v_add_f32_dpp v25, v25, v25 row_ror:8 row_mask:0xf bank_mask:0xf
  s_nop 1
  v_add_f32_dpp v25, v25, v25 row_ror:4 row_mask:0xf bank_mask:0xf
  s_nop 1
  v_add_f32_dpp v25, v25, v25 row_ror:2 row_mask:0xf bank_mask:0xf
  s_nop 1
  v_add_f32_dpp v25, v25, v25 row_ror:1 row_mask:0xf bank_mask:0xf
  v_mov_b32 v26, v25
  s_nop 1
  v_permlane16_swap_b32 v25, v26
  s_nop 1
  v_add_f32 v25, v25, v26
  v_mov_b32 v26, v25
  s_nop 1
  v_permlane32_swap_b32 v25, v26
  s_nop 1
  v_add_f32 v25, v25, v26
  v_mul_f32 v25, 0x3ae38e39, v25
  v_sub_f32 v26, v2, v25
  v_mul_f32 v27, v26, v26
  v_sub_f32 v26, v3, v25
  v_fmac_f32 v27, v26, v26
  v_sub_f32 v26, v4, v25
  v_fmac_f32 v27, v26, v26
  v_sub_f32 v26, v5, v25
  v_fmac_f32 v27, v26, v26
  v_sub_f32 v26, v6, v25
  v_fmac_f32 v27, v26, v26
  v_sub_f32 v26, v7, v25
  v_fmac_f32 v27, v26, v26
  v_sub_f32 v26, v8, v25
  v_fmac_f32 v27, v26, v26
  v_sub_f32 v26, v9, v25
  v_fmac_f32 v27, v26, v26
  v_sub_f32 v26, v10, v25
  v_cndmask_b32 v26, 0, v26, s[60:61]
  v_fmac_f32 v27, v26, v26
  v_sub_f32 v26, v11, v25
  v_cndmask_b32 v26, 0, v26, s[60:61]
  v_fmac_f32 v27, v26, v26
  s_nop 1
  v_add_f32_dpp v27, v27, v27 row_ror:8 row_mask:0xf bank_mask:0xf
  s_nop 1
  v_add_f32_dpp v27, v27, v27 row_ror:4 row_mask:0xf bank_mask:0xf
  s_nop 1
  v_add_f32_dpp v27, v27, v27 row_ror:2 row_mask:0xf bank_mask:0xf
  s_nop 1
  v_add_f32_dpp v27, v27, v27 row_ror:1 row_mask:0xf bank_mask:0xf
  v_mov_b32 v26, v27
  s_nop 1
  v_permlane16_swap_b32 v27, v26
  s_nop 1
  v_add_f32 v27, v27, v26
  v_mov_b32 v26, v27
  s_nop 1
  v_permlane32_swap_b32 v27, v26
  s_nop 1
  v_add_f32 v27, v27, v26
  v_mul_f32 v27, 0x3ae38e39, v27
  v_cvt_pk_bf16_f32 v26, v25, v27
  v_lshlrev_b32 v25, 16, v26
  v_and_b32 v27, s80, v26
  v_add_f32 v27, 0x3727c5ac, v27
  v_cvt_pk_bf16_f32 v27, v27, v27
  v_and_b32 v27, s80, v27
  v_sqrt_f32 v27, v27
  s_nop 0
  v_cvt_pk_bf16_f32 v27, v27, v27
  v_and_b32 v27, s80, v27
  v_rcp_f32 v27, v27
  v_sub_f32 v2, v2, v25
  v_sub_f32 v3, v3, v25
  v_cvt_pk_bf16_f32 v26, v2, v3
  v_lshlrev_b32 v2, 16, v26
  v_and_b32 v3, s80, v26
  v_mul_f32 v2, v2, v27
  v_mul_f32 v3, v3, v27
  v_cvt_pk_bf16_f32 v12, v2, v3
  v_lshlrev_b32 v2, 16, v12
  v_and_b32 v3, s80, v12
  ds_write_b32 v44, v12
  ds_write_b32 v44, v12 offset:72
  v_sub_f32 v4, v4, v25
  v_sub_f32 v5, v5, v25
  v_cvt_pk_bf16_f32 v26, v4, v5
  v_lshlrev_b32 v4, 16, v26
  v_and_b32 v5, s80, v26
  v_mul_f32 v4, v4, v27
  v_mul_f32 v5, v5, v27
  v_cvt_pk_bf16_f32 v13, v4, v5
  v_lshlrev_b32 v4, 16, v13
  v_and_b32 v5, s80, v13
  ds_write_b32 v45, v13
  ds_write_b32 v45, v13 offset:72
  v_sub_f32 v6, v6, v25
  v_sub_f32 v7, v7, v25
  v_cvt_pk_bf16_f32 v26, v6, v7
  v_lshlrev_b32 v6, 16, v26
  v_and_b32 v7, s80, v26
  v_mul_f32 v6, v6, v27
  v_mul_f32 v7, v7, v27
  v_cvt_pk_bf16_f32 v14, v6, v7
  v_lshlrev_b32 v6, 16, v14
  v_and_b32 v7, s80, v14
  ds_write_b32 v46, v14
  ds_write_b32 v46, v14 offset:72
  v_sub_f32 v8, v8, v25
  v_sub_f32 v9, v9, v25
  v_cvt_pk_bf16_f32 v26, v8, v9
  v_lshlrev_b32 v8, 16, v26
  v_and_b32 v9, s80, v26
  v_mul_f32 v8, v8, v27
  v_mul_f32 v9, v9, v27
  v_cvt_pk_bf16_f32 v15, v8, v9
  v_lshlrev_b32 v8, 16, v15
  v_and_b32 v9, s80, v15
  ds_write_b32 v47, v15
  ds_write_b32 v47, v15 offset:72
  v_sub_f32 v10, v10, v25
  v_sub_f32 v11, v11, v25
  v_cvt_pk_bf16_f32 v26, v10, v11
  v_lshlrev_b32 v10, 16, v26
  v_and_b32 v11, s80, v26
  v_mul_f32 v10, v10, v27
  v_mul_f32 v11, v11, v27
  v_cvt_pk_bf16_f32 v16, v10, v11
  v_lshlrev_b32 v10, 16, v16
  v_and_b32 v11, s80, v16
  s_mov_b32 exec_hi, 0
  ds_write_b32 v48, v16
  ds_write_b32 v48, v16 offset:72
  s_mov_b64 exec, -1
  v_cndmask_b32 v10, 0, v10, s[60:61]
  v_cndmask_b32 v11, 0, v11, s[60:61]
  s_waitcnt lgkmcnt(0)
  ds_read2_b32 v[72:73], v94 offset0:0 offset1:1
  ds_read2_b32 v[74:75], v94 offset0:2 offset1:3
  ds_read2_b32 v[76:77], v94 offset0:4 offset1:5
  ds_read2_b32 v[78:79], v94 offset0:6 offset1:7
  ds_read2_b32 v[80:81], v94 offset0:8 offset1:9
  ds_read2_b32 v[82:83], v94 offset0:10 offset1:11
  ds_read2_b32 v[84:85], v94 offset0:12 offset1:13
  ds_read2_b32 v[86:87], v94 offset0:14 offset1:15
  ds_read2_b32 v[88:89], v94 offset0:16 offset1:17
  s_mul_i32 s44, s47, 9216
  s_waitcnt lgkmcnt(0)
  buffer_load_dwordx4 v[96:99], v91, s[12:15], s44 offen
  buffer_load_dwordx4 v[100:103], v92, s[12:15], s44 offen
  s_add_u32 s44, s44, 9216
  s_cmp_ge_u32 s44, 331776
  s_cselect_b32 s44, 0, s44
  s_waitcnt vmcnt(1)
  buffer_load_dwordx4 v[104:107], v91, s[12:15], s44 offen
  s_waitcnt vmcnt(1)
  buffer_load_dwordx4 v[108:111], v92, s[12:15], s44 offen
  s_add_u32 s44, s44, 9216
  s_cmp_ge_u32 s44, 331776
  s_cselect_b32 s44, 0, s44
  v_perm_b32 v36, v72, v72, v28
  v_perm_b32 v37, v72, v72, v29
  v_perm_b32 v38, v72, v72, v30
  v_perm_b32 v39, v72, v72, v31
  s_nop 1
  v_mfma_f32_16x16x32_bf16 v[64:67], v[36:39], v[96:99], 0
  v_mfma_f32_16x16x32_bf16 v[68:71], v[36:39], v[100:103], 0
  s_waitcnt vmcnt(1)
  buffer_load_dwordx4 v[112:115], v91, s[12:15], s44 offen
  s_waitcnt vmcnt(1)
  buffer_load_dwordx4 v[116:119], v92, s[12:15], s44 offen
  s_add_u32 s44, s44, 9216
  s_cmp_ge_u32 s44, 331776
  s_cselect_b32 s44, 0, s44
  v_perm_b32 v40, v72, v72, v32
  v_perm_b32 v41, v72, v72, v33
  v_perm_b32 v42, v72, v72, v34
  v_perm_b32 v43, v72, v72, v35
  s_nop 1
  v_mfma_f32_16x16x32_bf16 v[64:67], v[40:43], v[104:107], v[64:67]
  v_mfma_f32_16x16x32_bf16 v[68:71], v[40:43], v[108:111], v[68:71]
  s_waitcnt vmcnt(1)
  buffer_load_dwordx4 v[120:123], v91, s[12:15], s44 offen
  s_waitcnt vmcnt(1)
  buffer_load_dwordx4 v[124:127], v92, s[12:15], s44 offen
  s_add_u32 s44, s44, 9216
  s_cmp_ge_u32 s44, 331776
  s_cselect_b32 s44, 0, s44
  v_perm_b32 v36, v73, v73, v28
  v_perm_b32 v37, v73, v73, v29
  v_perm_b32 v38, v73, v73, v30
  v_perm_b32 v39, v73, v73, v31
  s_nop 1
  v_mfma_f32_16x16x32_bf16 v[64:67], v[36:39], v[112:115], v[64:67]
  v_mfma_f32_16x16x32_bf16 v[68:71], v[36:39], v[116:119], v[68:71]
  s_waitcnt vmcnt(1)
  buffer_load_dwordx4 v[96:99], v91, s[12:15], s44 offen
  s_waitcnt vmcnt(1)
  buffer_load_dwordx4 v[100:103], v92, s[12:15], s44 offen
  s_add_u32 s44, s44, 9216
  s_cmp_ge_u32 s44, 331776
  s_cselect_b32 s44, 0, s44
  v_perm_b32 v40, v73, v73, v32
  v_perm_b32 v41, v73, v73, v33
  v_perm_b32 v42, v73, v73, v34
  v_perm_b32 v43, v73, v73, v35
  s_nop 1
  v_mfma_f32_16x16x32_bf16 v[64:67], v[40:43], v[120:123], v[64:67]
  v_mfma_f32_16x16x32_bf16 v[68:71], v[40:43], v[124:127], v[68:71]
  s_waitcnt vmcnt(1)
  buffer_load_dwordx4 v[104:107], v91, s[12:15], s44 offen
  s_waitcnt vmcnt(1)
  buffer_load_dwordx4 v[108:111], v92, s[12:15], s44 offen
  s_add_u32 s44, s44, 9216
  s_cmp_ge_u32 s44, 331776
  s_cselect_b32 s44, 0, s44
  v_perm_b32 v36, v74, v74, v28
  v_perm_b32 v37, v74, v74, v29
  v_perm_b32 v38, v74, v74, v30
  v_perm_b32 v39, v74, v74, v31
  s_nop 1
  v_mfma_f32_16x16x32_bf16 v[64:67], v[36:39], v[96:99], v[64:67]
  v_mfma_f32_16x16x32_bf16 v[68:71], v[36:39], v[100:103], v[68:71]
  s_waitcnt vmcnt(1)
  buffer_load_dwordx4 v[112:115], v91, s[12:15], s44 offen
  s_waitcnt vmcnt(1)
  buffer_load_dwordx4 v[116:119], v92, s[12:15], s44 offen
  s_add_u32 s44, s44, 9216
  s_cmp_ge_u32 s44, 331776
  s_cselect_b32 s44, 0, s44
  v_perm_b32 v40, v74, v74, v32
  v_perm_b32 v41, v74, v74, v33
  v_perm_b32 v42, v74, v74, v34
  v_perm_b32 v43, v74, v74, v35
  s_nop 1
  v_mfma_f32_16x16x32_bf16 v[64:67], v[40:43], v[104:107], v[64:67]
  v_mfma_f32_16x16x32_bf16 v[68:71], v[40:43], v[108:111], v[68:71]
  s_waitcnt vmcnt(1)
  buffer_load_dwordx4 v[120:123], v91, s[12:15], s44 offen
  s_waitcnt vmcnt(1)
  buffer_load_dwordx4 v[124:127], v92, s[12:15], s44 offen
  s_add_u32 s44, s44, 9216
  s_cmp_ge_u32 s44, 331776
  s_cselect_b32 s44, 0, s44
  v_perm_b32 v36, v75, v75, v28
  v_perm_b32 v37, v75, v75, v29
  v_perm_b32 v38, v75, v75, v30
  v_perm_b32 v39, v75, v75, v31
  s_nop 1
  v_mfma_f32_16x16x32_bf16 v[64:67], v[36:39], v[112:115], v[64:67]
  v_mfma_f32_16x16x32_bf16 v[68:71], v[36:39], v[116:119], v[68:71]
  s_waitcnt vmcnt(1)
  buffer_load_dwordx4 v[96:99], v91, s[12:15], s44 offen
  s_waitcnt vmcnt(1)
  buffer_load_dwordx4 v[100:103], v92, s[12:15], s44 offen
  s_add_u32 s44, s44, 9216
  s_cmp_ge_u32 s44, 331776
  s_cselect_b32 s44, 0, s44
  v_perm_b32 v40, v75, v75, v32
  v_perm_b32 v41, v75, v75, v33
  v_perm_b32 v42, v75, v75, v34
  v_perm_b32 v43, v75, v75, v35
  s_nop 1
  v_mfma_f32_16x16x32_bf16 v[64:67], v[40:43], v[120:123], v[64:67]
  v_mfma_f32_16x16x32_bf16 v[68:71], v[40:43], v[124:127], v[68:71]
  s_waitcnt vmcnt(1)
  buffer_load_dwordx4 v[104:107], v91, s[12:15], s44 offen
  s_waitcnt vmcnt(1)
  buffer_load_dwordx4 v[108:111], v92, s[12:15], s44 offen
  s_add_u32 s44, s44, 9216
  s_cmp_ge_u32 s44, 331776
  s_cselect_b32 s44, 0, s44
  v_perm_b32 v36, v76, v76, v28
  v_perm_b32 v37, v76, v76, v29
  v_perm_b32 v38, v76, v76, v30
  v_perm_b32 v39, v76, v76, v31
  s_nop 1
  v_mfma_f32_16x16x32_bf16 v[64:67], v[36:39], v[96:99], v[64:67]
  v_mfma_f32_16x16x32_bf16 v[68:71], v[36:39], v[100:103], v[68:71]
  s_waitcnt vmcnt(1)
  buffer_load_dwordx4 v[112:115], v91, s[12:15], s44 offen
  s_waitcnt vmcnt(1)
  buffer_load_dwordx4 v[116:119], v92, s[12:15], s44 offen
  s_add_u32 s44, s44, 9216
  s_cmp_ge_u32 s44, 331776
  s_cselect_b32 s44, 0, s44
  v_perm_b32 v40, v76, v76, v32
  v_perm_b32 v41, v76, v76, v33
  v_perm_b32 v42, v76, v76, v34
  v_perm_b32 v43, v76, v76, v35
  s_nop 1
  v_mfma_f32_16x16x32_bf16 v[64:67], v[40:43], v[104:107], v[64:67]
  v_mfma_f32_16x16x32_bf16 v[68:71], v[40:43], v[108:111], v[68:71]
  s_waitcnt vmcnt(1)
  buffer_load_dwordx4 v[120:123], v91, s[12:15], s44 offen
  s_waitcnt vmcnt(1)
  buffer_load_dwordx4 v[124:127], v92, s[12:15], s44 offen
  s_add_u32 s44, s44, 9216
  s_cmp_ge_u32 s44, 331776
  s_cselect_b32 s44, 0, s44
  v_perm_b32 v36, v77, v77, v28
  v_perm_b32 v37, v77, v77, v29
  v_perm_b32 v38, v77, v77, v30
  v_perm_b32 v39, v77, v77, v31
  s_nop 1
  v_mfma_f32_16x16x32_bf16 v[64:67], v[36:39], v[112:115], v[64:67]
  v_mfma_f32_16x16x32_bf16 v[68:71], v[36:39], v[116:119], v[68:71]
  s_waitcnt vmcnt(1)
  buffer_load_dwordx4 v[96:99], v91, s[12:15], s44 offen
  s_waitcnt vmcnt(1)
  buffer_load_dwordx4 v[100:103], v92, s[12:15], s44 offen
  s_add_u32 s44, s44, 9216
  s_cmp_ge_u32 s44, 331776
  s_cselect_b32 s44, 0, s44
  v_perm_b32 v40, v77, v77, v32
  v_perm_b32 v41, v77, v77, v33
  v_perm_b32 v42, v77, v77, v34
  v_perm_b32 v43, v77, v77, v35
  s_nop 1
  v_mfma_f32_16x16x32_bf16 v[64:67], v[40:43], v[120:123], v[64:67]
  v_mfma_f32_16x16x32_bf16 v[68:71], v[40:43], v[124:127], v[68:71]
  s_waitcnt vmcnt(1)
  buffer_load_dwordx4 v[104:107], v91, s[12:15], s44 offen
  s_waitcnt vmcnt(1)
  buffer_load_dwordx4 v[108:111], v92, s[12:15], s44 offen
  s_add_u32 s44, s44, 9216
  s_cmp_ge_u32 s44, 331776
  s_cselect_b32 s44, 0, s44
  v_perm_b32 v36, v78, v78, v28
  v_perm_b32 v37, v78, v78, v29
  v_perm_b32 v38, v78, v78, v30
  v_perm_b32 v39, v78, v78, v31
  s_nop 1
  v_mfma_f32_16x16x32_bf16 v[64:67], v[36:39], v[96:99], v[64:67]
  v_mfma_f32_16x16x32_bf16 v[68:71], v[36:39], v[100:103], v[68:71]
  s_waitcnt vmcnt(1)
  buffer_load_dwordx4 v[112:115], v91, s[12:15], s44 offen
  s_waitcnt vmcnt(1)
  buffer_load_dwordx4 v[116:119], v92, s[12:15], s44 offen
  s_add_u32 s44, s44, 9216
  s_cmp_ge_u32 s44, 331776
  s_cselect_b32 s44, 0, s44
  v_perm_b32 v40, v78, v78, v32
  v_perm_b32 v41, v78, v78, v33
  v_perm_b32 v42, v78, v78, v34
  v_perm_b32 v43, v78, v78, v35
  s_nop 1
  v_mfma_f32_16x16x32_bf16 v[64:67], v[40:43], v[104:107], v[64:67]
  v_mfma_f32_16x16x32_bf16 v[68:71], v[40:43], v[108:111], v[68:71]
  s_waitcnt vmcnt(1)
  buffer_load_dwordx4 v[120:123], v91, s[12:15], s44 offen
  s_waitcnt vmcnt(1)
  buffer_load_dwordx4 v[124:127], v92, s[12:15], s44 offen
  s_add_u32 s44, s44, 9216
  s_cmp_ge_u32 s44, 331776
  s_cselect_b32 s44, 0, s44
  v_perm_b32 v36, v79, v79, v28
  v_perm_b32 v37, v79, v79, v29
  v_perm_b32 v38, v79, v79, v30
  v_perm_b32 v39, v79, v79, v31
  s_nop 1
  v_mfma_f32_16x16x32_bf16 v[64:67], v[36:39], v[112:115], v[64:67]
  v_mfma_f32_16x16x32_bf16 v[68:71], v[36:39], v[116:119], v[68:71]
  s_waitcnt vmcnt(1)
  buffer_load_dwordx4 v[96:99], v91, s[12:15], s44 offen
  s_waitcnt vmcnt(1)
  buffer_load_dwordx4 v[100:103], v92, s[12:15], s44 offen
  s_add_u32 s44, s44, 9216
  s_cmp_ge_u32 s44, 331776
  s_cselect_b32 s44, 0, s44
  v_perm_b32 v40, v79, v79, v32
  v_perm_b32 v41, v79, v79, v33
  v_perm_b32 v42, v79, v79, v34
  v_perm_b32 v43, v79, v79, v35
  s_nop 1
  v_mfma_f32_16x16x32_bf16 v[64:67], v[40:43], v[120:123], v[64:67]
  v_mfma_f32_16x16x32_bf16 v[68:71], v[40:43], v[124:127], v[68:71]
  s_waitcnt vmcnt(1)
  buffer_load_dwordx4 v[104:107], v91, s[12:15], s44 offen
  s_waitcnt vmcnt(1)
  buffer_load_dwordx4 v[108:111], v92, s[12:15], s44 offen
  s_add_u32 s44, s44, 9216
  s_cmp_ge_u32 s44, 331776
  s_cselect_b32 s44, 0, s44
  v_perm_b32 v36, v80, v80, v28
  v_perm_b32 v37, v80, v80, v29
  v_perm_b32 v38, v80, v80, v30
  v_perm_b32 v39, v80, v80, v31
  s_nop 1
  v_mfma_f32_16x16x32_bf16 v[64:67], v[36:39], v[96:99], v[64:67]
  v_mfma_f32_16x16x32_bf16 v[68:71], v[36:39], v[100:103], v[68:71]
  s_waitcnt vmcnt(1)
  buffer_load_dwordx4 v[112:115], v91, s[12:15], s44 offen
  s_waitcnt vmcnt(1)
  buffer_load_dwordx4 v[116:119], v92, s[12:15], s44 offen
  s_add_u32 s44, s44, 9216
  s_cmp_ge_u32 s44, 331776
  s_cselect_b32 s44, 0, s44
  v_perm_b32 v40, v80, v80, v32
  v_perm_b32 v41, v80, v80, v33
  v_perm_b32 v42, v80, v80, v34
  v_perm_b32 v43, v80, v80, v35
  s_nop 1
  v_mfma_f32_16x16x32_bf16 v[64:67], v[40:43], v[104:107], v[64:67]
  v_mfma_f32_16x16x32_bf16 v[68:71], v[40:43], v[108:111], v[68:71]
  s_waitcnt vmcnt(1)
  buffer_load_dwordx4 v[120:123], v91, s[12:15], s44 offen
  s_waitcnt vmcnt(1)
  buffer_load_dwordx4 v[124:127], v92, s[12:15], s44 offen
  s_add_u32 s44, s44, 9216
  s_cmp_ge_u32 s44, 331776
  s_cselect_b32 s44, 0, s44
  v_perm_b32 v36, v81, v81, v28
  v_perm_b32 v37, v81, v81, v29
  v_perm_b32 v38, v81, v81, v30
  v_perm_b32 v39, v81, v81, v31
  s_nop 1
  v_mfma_f32_16x16x32_bf16 v[64:67], v[36:39], v[112:115], v[64:67]
  v_mfma_f32_16x16x32_bf16 v[68:71], v[36:39], v[116:119], v[68:71]
  s_waitcnt vmcnt(1)
  buffer_load_dwordx4 v[96:99], v91, s[12:15], s44 offen
  s_waitcnt vmcnt(1)
  buffer_load_dwordx4 v[100:103], v92, s[12:15], s44 offen
  s_add_u32 s44, s44, 9216
  s_cmp_ge_u32 s44, 331776
  s_cselect_b32 s44, 0, s44
  v_perm_b32 v40, v81, v81, v32
  v_perm_b32 v41, v81, v81, v33
  v_perm_b32 v42, v81, v81, v34
  v_perm_b32 v43, v81, v81, v35
  s_nop 1
  v_mfma_f32_16x16x32_bf16 v[64:67], v[40:43], v[120:123], v[64:67]
  v_mfma_f32_16x16x32_bf16 v[68:71], v[40:43], v[124:127], v[68:71]
  s_waitcnt vmcnt(1)
  buffer_load_dwordx4 v[104:107], v91, s[12:15], s44 offen
  s_waitcnt vmcnt(1)
  buffer_load_dwordx4 v[108:111], v92, s[12:15], s44 offen
  s_add_u32 s44, s44, 9216
  s_cmp_ge_u32 s44, 331776
  s_cselect_b32 s44, 0, s44
  v_perm_b32 v36, v82, v82, v28
  v_perm_b32 v37, v82, v82, v29
  v_perm_b32 v38, v82, v82, v30
  v_perm_b32 v39, v82, v82, v31
  s_nop 1
  v_mfma_f32_16x16x32_bf16 v[64:67], v[36:39], v[96:99], v[64:67]
  v_mfma_f32_16x16x32_bf16 v[68:71], v[36:39], v[100:103], v[68:71]
  s_waitcnt vmcnt(1)
  buffer_load_dwordx4 v[112:115], v91, s[12:15], s44 offen
  s_waitcnt vmcnt(1)
  buffer_load_dwordx4 v[116:119], v92, s[12:15], s44 offen
  s_add_u32 s44, s44, 9216
  s_cmp_ge_u32 s44, 331776
  s_cselect_b32 s44, 0, s44
  v_perm_b32 v40, v82, v82, v32
  v_perm_b32 v41, v82, v82, v33
  v_perm_b32 v42, v82, v82, v34
  v_perm_b32 v43, v82, v82, v35
  s_nop 1
  v_mfma_f32_16x16x32_bf16 v[64:67], v[40:43], v[104:107], v[64:67]
  v_mfma_f32_16x16x32_bf16 v[68:71], v[40:43], v[108:111], v[68:71]
  s_waitcnt vmcnt(1)
  buffer_load_dwordx4 v[120:123], v91, s[12:15], s44 offen
  s_waitcnt vmcnt(1)
  buffer_load_dwordx4 v[124:127], v92, s[12:15], s44 offen
  s_add_u32 s44, s44, 9216
  s_cmp_ge_u32 s44, 331776
  s_cselect_b32 s44, 0, s44
  v_perm_b32 v36, v83, v83, v28
  v_perm_b32 v37, v83, v83, v29
  v_perm_b32 v38, v83, v83, v30
  v_perm_b32 v39, v83, v83, v31
  s_nop 1
  v_mfma_f32_16x16x32_bf16 v[64:67], v[36:39], v[112:115], v[64:67]
  v_mfma_f32_16x16x32_bf16 v[68:71], v[36:39], v[116:119], v[68:71]
  s_waitcnt vmcnt(1)
  buffer_load_dwordx4 v[96:99], v91, s[12:15], s44 offen
  s_waitcnt vmcnt(1)
  buffer_load_dwordx4 v[100:103], v92, s[12:15], s44 offen
  s_add_u32 s44, s44, 9216
  s_cmp_ge_u32 s44, 331776
  s_cselect_b32 s44, 0, s44
  v_perm_b32 v40, v83, v83, v32
  v_perm_b32 v41, v83, v83, v33
  v_perm_b32 v42, v83, v83, v34
  v_perm_b32 v43, v83, v83, v35
  s_nop 1
  v_mfma_f32_16x16x32_bf16 v[64:67], v[40:43], v[120:123], v[64:67]
  v_mfma_f32_16x16x32_bf16 v[68:71], v[40:43], v[124:127], v[68:71]
  s_waitcnt vmcnt(1)
  buffer_load_dwordx4 v[104:107], v91, s[12:15], s44 offen
  s_waitcnt vmcnt(1)
  buffer_load_dwordx4 v[108:111], v92, s[12:15], s44 offen
  s_add_u32 s44, s44, 9216
  s_cmp_ge_u32 s44, 331776
  s_cselect_b32 s44, 0, s44
  v_perm_b32 v36, v84, v84, v28
  v_perm_b32 v37, v84, v84, v29
  v_perm_b32 v38, v84, v84, v30
  v_perm_b32 v39, v84, v84, v31
  s_nop 1
  v_mfma_f32_16x16x32_bf16 v[64:67], v[36:39], v[96:99], v[64:67]
  v_mfma_f32_16x16x32_bf16 v[68:71], v[36:39], v[100:103], v[68:71]
  s_waitcnt vmcnt(1)
  buffer_load_dwordx4 v[112:115], v91, s[12:15], s44 offen
  s_waitcnt vmcnt(1)
  buffer_load_dwordx4 v[116:119], v92, s[12:15], s44 offen
  s_add_u32 s44, s44, 9216
  s_cmp_ge_u32 s44, 331776
  s_cselect_b32 s44, 0, s44
  v_perm_b32 v40, v84, v84, v32
  v_perm_b32 v41, v84, v84, v33
  v_perm_b32 v42, v84, v84, v34
  v_perm_b32 v43, v84, v84, v35
  s_nop 1
  v_mfma_f32_16x16x32_bf16 v[64:67], v[40:43], v[104:107], v[64:67]
  v_mfma_f32_16x16x32_bf16 v[68:71], v[40:43], v[108:111], v[68:71]
  s_waitcnt vmcnt(1)
  buffer_load_dwordx4 v[120:123], v91, s[12:15], s44 offen
  s_waitcnt vmcnt(1)
  buffer_load_dwordx4 v[124:127], v92, s[12:15], s44 offen
  s_add_u32 s44, s44, 9216
  s_cmp_ge_u32 s44, 331776
  s_cselect_b32 s44, 0, s44
  v_perm_b32 v36, v85, v85, v28
  v_perm_b32 v37, v85, v85, v29
  v_perm_b32 v38, v85, v85, v30
  v_perm_b32 v39, v85, v85, v31
  s_nop 1
  v_mfma_f32_16x16x32_bf16 v[64:67], v[36:39], v[112:115], v[64:67]
  v_mfma_f32_16x16x32_bf16 v[68:71], v[36:39], v[116:119], v[68:71]
  s_waitcnt vmcnt(1)
  buffer_load_dwordx4 v[96:99], v91, s[12:15], s44 offen
  s_waitcnt vmcnt(1)
  buffer_load_dwordx4 v[100:103], v92, s[12:15], s44 offen
  s_add_u32 s44, s44, 9216
  s_cmp_ge_u32 s44, 331776
  s_cselect_b32 s44, 0, s44
  v_perm_b32 v40, v85, v85, v32
  v_perm_b32 v41, v85, v85, v33
  v_perm_b32 v42, v85, v85, v34
  v_perm_b32 v43, v85, v85, v35
  s_nop 1
  v_mfma_f32_16x16x32_bf16 v[64:67], v[40:43], v[120:123], v[64:67]
  v_mfma_f32_16x16x32_bf16 v[68:71], v[40:43], v[124:127], v[68:71]
  s_waitcnt vmcnt(1)
  buffer_load_dwordx4 v[104:107], v91, s[12:15], s44 offen
  s_waitcnt vmcnt(1)
  buffer_load_dwordx4 v[108:111], v92, s[12:15], s44 offen
  s_add_u32 s44, s44, 9216
  s_cmp_ge_u32 s44, 331776
  s_cselect_b32 s44, 0, s44
  v_perm_b32 v36, v86, v86, v28
  v_perm_b32 v37, v86, v86, v29
  v_perm_b32 v38, v86, v86, v30
  v_perm_b32 v39, v86, v86, v31
  s_nop 1
  v_mfma_f32_16x16x32_bf16 v[64:67], v[36:39], v[96:99], v[64:67]
  v_mfma_f32_16x16x32_bf16 v[68:71], v[36:39], v[100:103], v[68:71]
  s_waitcnt vmcnt(1)
  buffer_load_dwordx4 v[112:115], v91, s[12:15], s44 offen
  s_waitcnt vmcnt(1)
  buffer_load_dwordx4 v[116:119], v92, s[12:15], s44 offen
  s_add_u32 s44, s44, 9216
  s_cmp_ge_u32 s44, 331776
  s_cselect_b32 s44, 0, s44
  v_perm_b32 v40, v86, v86, v32
  v_perm_b32 v41, v86, v86, v33
  v_perm_b32 v42, v86, v86, v34
  v_perm_b32 v43, v86, v86, v35
  s_nop 1
  v_mfma_f32_16x16x32_bf16 v[64:67], v[40:43], v[104:107], v[64:67]
  v_mfma_f32_16x16x32_bf16 v[68:71], v[40:43], v[108:111], v[68:71]
  s_waitcnt vmcnt(1)
  buffer_load_dwordx4 v[120:123], v91, s[12:15], s44 offen
  s_waitcnt vmcnt(1)
  buffer_load_dwordx4 v[124:127], v92, s[12:15], s44 offen
  s_add_u32 s44, s44, 9216
  s_cmp_ge_u32 s44, 331776
  s_cselect_b32 s44, 0, s44
  v_perm_b32 v36, v87, v87, v28
  v_perm_b32 v37, v87, v87, v29
  v_perm_b32 v38, v87, v87, v30
  v_perm_b32 v39, v87, v87, v31
  s_nop 1
  v_mfma_f32_16x16x32_bf16 v[64:67], v[36:39], v[112:115], v[64:67]
  v_mfma_f32_16x16x32_bf16 v[68:71], v[36:39], v[116:119], v[68:71]
  s_waitcnt vmcnt(1)
  buffer_load_dwordx4 v[96:99], v91, s[12:15], s44 offen
  s_waitcnt vmcnt(1)
  buffer_load_dwordx4 v[100:103], v92, s[12:15], s44 offen
  s_add_u32 s44, s44, 9216
  s_cmp_ge_u32 s44, 331776
  s_cselect_b32 s44, 0, s44
  v_perm_b32 v40, v87, v87, v32
  v_perm_b32 v41, v87, v87, v33
  v_perm_b32 v42, v87, v87, v34
  v_perm_b32 v43, v87, v87, v35
  s_nop 1
  v_mfma_f32_16x16x32_bf16 v[64:67], v[40:43], v[120:123], v[64:67]
  v_mfma_f32_16x16x32_bf16 v[68:71], v[40:43], v[124:127], v[68:71]
  s_waitcnt vmcnt(1)
  buffer_load_dwordx4 v[104:107], v91, s[12:15], s44 offen
  s_waitcnt vmcnt(1)
  buffer_load_dwordx4 v[108:111], v92, s[12:15], s44 offen
  s_add_u32 s44, s44, 9216
  s_cmp_ge_u32 s44, 331776
  s_cselect_b32 s44, 0, s44
  v_perm_b32 v36, v88, v88, v28
  v_perm_b32 v37, v88, v88, v29
  v_perm_b32 v38, v88, v88, v30
  v_perm_b32 v39, v88, v88, v31
  s_nop 1
  v_mfma_f32_16x16x32_bf16 v[64:67], v[36:39], v[96:99], v[64:67]
  v_mfma_f32_16x16x32_bf16 v[68:71], v[36:39], v[100:103], v[68:71]
  s_waitcnt vmcnt(1)
  buffer_load_dwordx4 v[112:115], v91, s[12:15], s44 offen
  s_waitcnt vmcnt(1)
  buffer_load_dwordx4 v[116:119], v92, s[12:15], s44 offen
  s_add_u32 s44, s44, 9216
  s_cmp_ge_u32 s44, 331776
  s_cselect_b32 s44, 0, s44
  v_perm_b32 v40, v88, v88, v32
  v_perm_b32 v41, v88, v88, v33
  v_perm_b32 v42, v88, v88, v34
  v_perm_b32 v43, v88, v88, v35
  s_nop 1
  v_mfma_f32_16x16x32_bf16 v[64:67], v[40:43], v[104:107], v[64:67]
  v_mfma_f32_16x16x32_bf16 v[68:71], v[40:43], v[108:111], v[68:71]
  s_waitcnt vmcnt(1)
  buffer_load_dwordx4 v[120:123], v91, s[12:15], s44 offen
  s_waitcnt vmcnt(1)
  buffer_load_dwordx4 v[124:127], v92, s[12:15], s44 offen
  v_perm_b32 v36, v89, v89, v28
  v_perm_b32 v37, v89, v89, v29
  v_perm_b32 v38, v89, v89, v30
  v_perm_b32 v39, v89, v89, v31
  s_nop 1
  v_mfma_f32_16x16x32_bf16 v[64:67], v[36:39], v[112:115], v[64:67]
  v_mfma_f32_16x16x32_bf16 v[68:71], v[36:39], v[116:119], v[68:71]
  s_waitcnt vmcnt(0)
  v_perm_b32 v40, v89, v89, v32
  v_perm_b32 v41, v89, v89, v33
  v_perm_b32 v42, v89, v89, v34
  v_perm_b32 v43, v89, v89, v35
  s_nop 1
  v_mfma_f32_16x16x32_bf16 v[64:67], v[40:43], v[120:123], v[64:67]
  v_mfma_f32_16x16x32_bf16 v[68:71], v[40:43], v[124:127], v[68:71]
  s_mul_i32 s40, s63, 288
  s_add_u32 s8, s26, s40
  s_addc_u32 s9, s27, 0
  s_mov_b32 s10, 288
  s_mov_b32 s11, 0x20000
  v_lshrrev_b32 v18, 4, v0
  v_mul_u32_u24 v19, 9, v18
  s_mul_i32 s42, s62, 36
  v_add_u32 v19, s42, v19
  v_lshlrev_b32 v20, 1, v19
  buffer_load_ushort v2, v20, s[8:11], 0 offen offset:0
  buffer_load_ushort v3, v20, s[8:11], 0 offen offset:2
  buffer_load_ushort v4, v20, s[8:11], 0 offen offset:4
  buffer_load_ushort v5, v20, s[8:11], 0 offen offset:6
  buffer_load_ushort v6, v20, s[8:11], 0 offen offset:8
  buffer_load_ushort v7, v20, s[8:11], 0 offen offset:10
  buffer_load_ushort v8, v20, s[8:11], 0 offen offset:12
  buffer_load_ushort v9, v20, s[8:11], 0 offen offset:14
  buffer_load_ushort v10, v20, s[8:11], 0 offen offset:16
  s_lshl_b32 s40, s62, 10
  s_add_u32 s40, s40, 134144
  v_add_u32 v17, s40, v95
  s_mov_b32 exec_hi, 0
  ds_write_b128 v17, v[64:67]
  ds_write_b128 v17, v[68:71] offset:512
  s_mov_b64 exec, -1
  s_mul_i32 s40, s63, 165888
  s_add_u32 s12, s28, s40
  s_addc_u32 s13, s29, 0
  s_mov_b32 s14, 165888
  s_mov_b32 s15, 0x20000
  v_and_b32 v21, 15, v0
  s_movk_i32 s43, 1152
  v_mul_lo_u32 v90, v19, s43
  v_lshl_add_u32 v90, v21, 4, v90
  v_add_u32 v91, 1024, v90
  v_mov_b32 v22, 0x7f000000
  v_cmp_gt_u32 vcc, 8, v21
  s_nop 1
  v_cndmask_b32 v91, v22, v91, vcc
  v_lshlrev_b32 v92, 2, v19
  v_add_u32 v92, 134144, v92
  v_mov_b32 v17, 150596
  v_mov_b32 v18, 1
  s_waitcnt lgkmcnt(0)
  s_mov_b64 exec, 1
  ds_add_u32 v17, v18
  s_mov_b64 exec, -1
L_hsync:
  ds_read_b32 v18, v17
  s_waitcnt lgkmcnt(0)
  v_readfirstlane_b32 s40, v18
  s_nop 3
  s_cmp_ge_u32 s40, 4
  s_cbranch_scc1 L_hsync_done
  s_sleep 4
  s_branch L_hsync
L_hsync_done:
  ds_read_b32 v72, v92 offset:0
  ds_read_b32 v17, v92 offset:1024
  ds_read_b32 v18, v92 offset:2048
  ds_read_b32 v19, v92 offset:3072
  s_waitcnt lgkmcnt(0)
  v_add_f32 v72, v72, v17
  v_add_f32 v18, v18, v19
  v_add_f32 v72, v72, v18
  ds_read_b32 v73, v92 offset:4
  ds_read_b32 v17, v92 offset:1028
  ds_read_b32 v18, v92 offset:2052
  ds_read_b32 v19, v92 offset:3076
  s_waitcnt lgkmcnt(0)
  v_add_f32 v73, v73, v17
  v_add_f32 v18, v18, v19
  v_add_f32 v73, v73, v18
  ds_read_b32 v74, v92 offset:8
  ds_read_b32 v17, v92 offset:1032
  ds_read_b32 v18, v92 offset:2056
  ds_read_b32 v19, v92 offset:3080
  s_waitcnt lgkmcnt(0)
  v_add_f32 v74, v74, v17
  v_add_f32 v18, v18, v19
  v_add_f32 v74, v74, v18
  ds_read_b32 v75, v92 offset:12
  ds_read_b32 v17, v92 offset:1036
  ds_read_b32 v18, v92 offset:2060
  ds_read_b32 v19, v92 offset:3084
  s_waitcnt lgkmcnt(0)
  v_add_f32 v75, v75, v17
  v_add_f32 v18, v18, v19
  v_add_f32 v75, v75, v18
  ds_read_b32 v76, v92 offset:16
  ds_read_b32 v17, v92 offset:1040
  ds_read_b32 v18, v92 offset:2064
  ds_read_b32 v19, v92 offset:3088
  s_waitcnt lgkmcnt(0)
  v_add_f32 v76, v76, v17
  v_add_f32 v18, v18, v19
  v_add_f32 v76, v76, v18
  ds_read_b32 v77, v92 offset:20
  ds_read_b32 v17, v92 offset:1044
  ds_read_b32 v18, v92 offset:2068
  ds_read_b32 v19, v92 offset:3092
  s_waitcnt lgkmcnt(0)
  v_add_f32 v77, v77, v17
  v_add_f32 v18, v18, v19
  v_add_f32 v77, v77, v18
  ds_read_b32 v78, v92 offset:24
  ds_read_b32 v17, v92 offset:1048
  ds_read_b32 v18, v92 offset:2072
  ds_read_b32 v19, v92 offset:3096
  s_waitcnt lgkmcnt(0)
  v_add_f32 v78, v78, v17
  v_add_f32 v18, v18, v19
  v_add_f32 v78, v78, v18
  ds_read_b32 v79, v92 offset:28
  ds_read_b32 v17, v92 offset:1052
  ds_read_b32 v18, v92 offset:2076
  ds_read_b32 v19, v92 offset:3100
  s_waitcnt lgkmcnt(0)
  v_add_f32 v79, v79, v17
  v_add_f32 v18, v18, v19
  v_add_f32 v79, v79, v18
  ds_read_b32 v80, v92 offset:32
  ds_read_b32 v17, v92 offset:1056
  ds_read_b32 v18, v92 offset:2080
  ds_read_b32 v19, v92 offset:3104
  s_waitcnt lgkmcnt(0)
  v_add_f32 v80, v80, v17
  v_add_f32 v18, v18, v19
  v_add_f32 v80, v80, v18
  s_waitcnt vmcnt(0)
  s_mov_b32 s40, 0x3d372713
  s_mov_b32 s41, 0xc0135761
  v_cvt_pk_bf16_f32 v72, v72, v72
  v_and_b32 v72, s80, v72
  v_lshlrev_b32 v2, 16, v2
  v_add_f32 v72, v72, v2
  v_cvt_pk_bf16_f32 v72, v72, v72
  v_and_b32 v72, s80, v72
  v_mul_f32 v17, v72, v72
  v_mul_f32 v17, v17, v72
  v_fma_f32 v17, v17, s40, v72
  v_mul_f32 v17, s41, v17
  v_exp_f32 v17, v17
  s_nop 0
  v_add_f32 v17, 1.0, v17
  v_rcp_f32 v17, v17
  s_nop 0
  v_mul_f32 v72, v72, v17
  v_cvt_pk_bf16_f32 v73, v73, v73
  v_and_b32 v73, s80, v73
  v_lshlrev_b32 v3, 16, v3
  v_add_f32 v73, v73, v3
  v_cvt_pk_bf16_f32 v73, v73, v73
  v_and_b32 v73, s80, v73
  v_mul_f32 v17, v73, v73
  v_mul_f32 v17, v17, v73
  v_fma_f32 v17, v17, s40, v73
  v_mul_f32 v17, s41, v17
  v_exp_f32 v17, v17
  s_nop 0
  v_add_f32 v17, 1.0, v17
  v_rcp_f32 v17, v17
  s_nop 0
  v_mul_f32 v73, v73, v17
  v_cvt_pk_bf16_f32 v74, v74, v74
  v_and_b32 v74, s80, v74
  v_lshlrev_b32 v4, 16, v4
  v_add_f32 v74, v74, v4
  v_cvt_pk_bf16_f32 v74, v74, v74
  v_and_b32 v74, s80, v74
  v_mul_f32 v17, v74, v74
  v_mul_f32 v17, v17, v74
  v_fma_f32 v17, v17, s40, v74
  v_mul_f32 v17, s41, v17
  v_exp_f32 v17, v17
  s_nop 0
  v_add_f32 v17, 1.0, v17
  v_rcp_f32 v17, v17
  s_nop 0
  v_mul_f32 v74, v74, v17
  v_cvt_pk_bf16_f32 v75, v75, v75
  v_and_b32 v75, s80, v75
  v_lshlrev_b32 v5, 16, v5
  v_add_f32 v75, v75, v5
  v_cvt_pk_bf16_f32 v75, v75, v75
  v_and_b32 v75, s80, v75
  v_mul_f32 v17, v75, v75
  v_mul_f32 v17, v17, v75
  v_fma_f32 v17, v17, s40, v75
  v_mul_f32 v17, s41, v17
  v_exp_f32 v17, v17
  s_nop 0
  v_add_f32 v17, 1.0, v17
  v_rcp_f32 v17, v17
  s_nop 0
  v_mul_f32 v75, v75, v17
  v_cvt_pk_bf16_f32 v76, v76, v76
  v_and_b32 v76, s80, v76
  v_lshlrev_b32 v6, 16, v6
  v_add_f32 v76, v76, v6
  v_cvt_pk_bf16_f32 v76, v76, v76
  v_and_b32 v76, s80, v76
  v_mul_f32 v17, v76, v76
  v_mul_f32 v17, v17, v76
  v_fma_f32 v17, v17, s40, v76
  v_mul_f32 v17, s41, v17
  v_exp_f32 v17, v17
  s_nop 0
  v_add_f32 v17, 1.0, v17
  v_rcp_f32 v17, v17
  s_nop 0
  v_mul_f32 v76, v76, v17
  v_cvt_pk_bf16_f32 v77, v77, v77
  v_and_b32 v77, s80, v77
  v_lshlrev_b32 v7, 16, v7
  v_add_f32 v77, v77, v7
  v_cvt_pk_bf16_f32 v77, v77, v77
  v_and_b32 v77, s80, v77
  v_mul_f32 v17, v77, v77
  v_mul_f32 v17, v17, v77
  v_fma_f32 v17, v17, s40, v77
  v_mul_f32 v17, s41, v17
  v_exp_f32 v17, v17
  s_nop 0
  v_add_f32 v17, 1.0, v17
  v_rcp_f32 v17, v17
  s_nop 0
  v_mul_f32 v77, v77, v17
  v_cvt_pk_bf16_f32 v78, v78, v78
  v_and_b32 v78, s80, v78
  v_lshlrev_b32 v8, 16, v8
  v_add_f32 v78, v78, v8
  v_cvt_pk_bf16_f32 v78, v78, v78
  v_and_b32 v78, s80, v78
  v_mul_f32 v17, v78, v78
  v_mul_f32 v17, v17, v78
  v_fma_f32 v17, v17, s40, v78
  v_mul_f32 v17, s41, v17
  v_exp_f32 v17, v17
  s_nop 0
  v_add_f32 v17, 1.0, v17
  v_rcp_f32 v17, v17
  s_nop 0
  v_mul_f32 v78, v78, v17
  v_cvt_pk_bf16_f32 v79, v79, v79
  v_and_b32 v79, s80, v79
  v_lshlrev_b32 v9, 16, v9
  v_add_f32 v79, v79, v9
  v_cvt_pk_bf16_f32 v79, v79, v79
  v_and_b32 v79, s80, v79
  v_mul_f32 v17, v79, v79
  v_mul_f32 v17, v17, v79
  v_fma_f32 v17, v17, s40, v79
  v_mul_f32 v17, s41, v17
  v_exp_f32 v17, v17
  s_nop 0
  v_add_f32 v17, 1.0, v17
  v_rcp_f32 v17, v17
  s_nop 0
  v_mul_f32 v79, v79, v17
  v_cvt_pk_bf16_f32 v80, v80, v80
  v_and_b32 v80, s80, v80
  v_lshlrev_b32 v10, 16, v10
  v_add_f32 v80, v80, v10
  v_cvt_pk_bf16_f32 v80, v80, v80
  v_and_b32 v80, s80, v80
  v_mul_f32 v17, v80, v80
  v_mul_f32 v17, v17, v80
  v_fma_f32 v17, v17, s40, v80
  v_mul_f32 v17, s41, v17
  v_exp_f32 v17, v17
  s_nop 0
  v_add_f32 v17, 1.0, v17
  v_rcp_f32 v17, v17
  s_nop 0
  v_mul_f32 v80, v80, v17
  v_cvt_pk_bf16_f32 v2, v72, v73
  v_cvt_pk_bf16_f32 v3, v74, v75
  v_cvt_pk_bf16_f32 v4, v76, v77
  v_cvt_pk_bf16_f32 v5, v78, v79
  v_cvt_pk_bf16_f32 v6, v80, v80
  s_movk_i32 s43, 0
  buffer_load_dwordx4 v[96:99], v90, s[12:15], s43 offen offset:0
  buffer_load_dwordx4 v[100:103], v90, s[12:15], s43 offen offset:256
  s_waitcnt vmcnt(1)
  buffer_load_dwordx4 v[104:107], v90, s[12:15], s43 offen offset:512
  s_waitcnt vmcnt(1)
  buffer_load_dwordx4 v[108:111], v90, s[12:15], s43 offen offset:768
  s_waitcnt vmcnt(1)
  buffer_load_dwordx4 v[112:115], v91, s[12:15], s43 offen
  s_waitcnt vmcnt(1)
  s_movk_i32 s43, 1152
  buffer_load_dwordx4 v[116:119], v90, s[12:15], s43 offen offset:0
  s_waitcnt vmcnt(1)
  buffer_load_dwordx4 v[120:123], v90, s[12:15], s43 offen offset:256
  v_perm_b32 v36, v2, v2, v28
  v_perm_b32 v37, v2, v2, v29
  v_perm_b32 v38, v2, v2, v30
  v_perm_b32 v39, v2, v2, v31
  s_nop 1
  v_mfma_f32_16x16x32_bf16 v[44:47], v[36:39], v[96:99], 0
  v_mfma_f32_16x16x32_bf16 v[48:51], v[36:39], v[100:103], 0
  v_mfma_f32_16x16x32_bf16 v[52:55], v[36:39], v[104:107], 0
  v_mfma_f32_16x16x32_bf16 v[56:59], v[36:39], v[108:111], 0
  v_mfma_f32_16x16x32_bf16 v[60:63], v[36:39], v[112:115], 0
  s_waitcnt vmcnt(1)
  buffer_load_dwordx4 v[124:127], v90, s[12:15], s43 offen offset:512
  s_waitcnt vmcnt(1)
  buffer_load_dwordx4 v[128:131], v90, s[12:15], s43 offen offset:768
  s_waitcnt vmcnt(1)
  buffer_load_dwordx4 v[132:135], v91, s[12:15], s43 offen
  s_waitcnt vmcnt(1)
  s_movk_i32 s43, 2304
  buffer_load_dwordx4 v[136:139], v90, s[12:15], s43 offen offset:0
  s_waitcnt vmcnt(1)
  buffer_load_dwordx4 v[140:143], v90, s[12:15], s43 offen offset:256
  v_perm_b32 v40, v2, v2, v32
  v_perm_b32 v41, v2, v2, v33
  v_perm_b32 v42, v2, v2, v34
  v_perm_b32 v43, v2, v2, v35
  s_nop 1
  v_mfma_f32_16x16x32_bf16 v[44:47], v[40:43], v[116:119], v[44:47]
  v_mfma_f32_16x16x32_bf16 v[48:51], v[40:43], v[120:123], v[48:51]
  v_mfma_f32_16x16x32_bf16 v[52:55], v[40:43], v[124:127], v[52:55]
  v_mfma_f32_16x16x32_bf16 v[56:59], v[40:43], v[128:131], v[56:59]
  v_mfma_f32_16x16x32_bf16 v[60:63], v[40:43], v[132:135], v[60:63]
  s_waitcnt vmcnt(1)
  buffer_load_dwordx4 v[144:147], v90, s[12:15], s43 offen offset:512
  s_waitcnt vmcnt(1)
  buffer_load_dwordx4 v[148:151], v90, s[12:15], s43 offen offset:768
  s_waitcnt vmcnt(1)
  buffer_load_dwordx4 v[152:155], v91, s[12:15], s43 offen
  s_waitcnt vmcnt(1)
  s_movk_i32 s43, 3456
  buffer_load_dwordx4 v[96:99], v90, s[12:15], s43 offen offset:0
  s_waitcnt vmcnt(1)
  buffer_load_dwordx4 v[100:103], v90, s[12:15], s43 offen offset:256
  v_perm_b32 v36, v3, v3, v28
  v_perm_b32 v37, v3, v3, v29
  v_perm_b32 v38, v3, v3, v30
  v_perm_b32 v39, v3, v3, v31
  s_nop 1
  v_mfma_f32_16x16x32_bf16 v[44:47], v[36:39], v[136:139], v[44:47]
  v_mfma_f32_16x16x32_bf16 v[48:51], v[36:39], v[140:143], v[48:51]
  v_mfma_f32_16x16x32_bf16 v[52:55], v[36:39], v[144:147], v[52:55]
  v_mfma_f32_16x16x32_bf16 v[56:59], v[36:39], v[148:151], v[56:59]
  v_mfma_f32_16x16x32_bf16 v[60:63], v[36:39], v[152:155], v[60:63]
  s_waitcnt vmcnt(1)
  buffer_load_dwordx4 v[104:107], v90, s[12:15], s43 offen offset:512
  s_waitcnt vmcnt(1)
  buffer_load_dwordx4 v[108:111], v90, s[12:15], s43 offen offset:768
  s_waitcnt vmcnt(1)
  buffer_load_dwordx4 v[112:115], v91, s[12:15], s43 offen
  s_waitcnt vmcnt(1)
  s_movk_i32 s43, 4608
  buffer_load_dwordx4 v[116:119], v90, s[12:15], s43 offen offset:0
  s_waitcnt vmcnt(1)
  buffer_load_dwordx4 v[120:123], v90, s[12:15], s43 offen offset:256
  v_perm_b32 v40, v3, v3, v32
  v_perm_b32 v41, v3, v3, v33
  v_perm_b32 v42, v3, v3, v34
  v_perm_b32 v43, v3, v3, v35
  s_nop 1
  v_mfma_f32_16x16x32_bf16 v[44:47], v[40:43], v[96:99], v[44:47]
  v_mfma_f32_16x16x32_bf16 v[48:51], v[40:43], v[100:103], v[48:51]
  v_mfma_f32_16x16x32_bf16 v[52:55], v[40:43], v[104:107], v[52:55]
  v_mfma_f32_16x16x32_bf16 v[56:59], v[40:43], v[108:111], v[56:59]
  v_mfma_f32_16x16x32_bf16 v[60:63], v[40:43], v[112:115], v[60:63]
  s_waitcnt vmcnt(1)
  buffer_load_dwordx4 v[124:127], v90, s[12:15], s43 offen offset:512
  s_waitcnt vmcnt(1)
  buffer_load_dwordx4 v[128:131], v90, s[12:15], s43 offen offset:768
  s_waitcnt vmcnt(1)
  buffer_load_dwordx4 v[132:135], v91, s[12:15], s43 offen
  s_waitcnt vmcnt(1)
  s_movk_i32 s43, 5760
  buffer_load_dwordx4 v[136:139], v90, s[12:15], s43 offen offset:0
  s_waitcnt vmcnt(1)
  buffer_load_dwordx4 v[140:143], v90, s[12:15], s43 offen offset:256
  v_perm_b32 v36, v4, v4, v28
  v_perm_b32 v37, v4, v4, v29
  v_perm_b32 v38, v4, v4, v30
  v_perm_b32 v39, v4, v4, v31
  s_nop 1
  v_mfma_f32_16x16x32_bf16 v[44:47], v[36:39], v[116:119], v[44:47]
  v_mfma_f32_16x16x32_bf16 v[48:51], v[36:39], v[120:123], v[48:51]
  v_mfma_f32_16x16x32_bf16 v[52:55], v[36:39], v[124:127], v[52:55]
  v_mfma_f32_16x16x32_bf16 v[56:59], v[36:39], v[128:131], v[56:59]
  v_mfma_f32_16x16x32_bf16 v[60:63], v[36:39], v[132:135], v[60:63]
  s_waitcnt vmcnt(1)
  buffer_load_dwordx4 v[144:147], v90, s[12:15], s43 offen offset:512
  s_waitcnt vmcnt(1)
  buffer_load_dwordx4 v[148:151], v90, s[12:15], s43 offen offset:768
  s_waitcnt vmcnt(1)
  buffer_load_dwordx4 v[152:155], v91, s[12:15], s43 offen
  s_waitcnt vmcnt(1)
  s_movk_i32 s43, 6912
  buffer_load_dwordx4 v[96:99], v90, s[12:15], s43 offen offset:0
  s_waitcnt vmcnt(1)
  buffer_load_dwordx4 v[100:103], v90, s[12:15], s43 offen offset:256
  v_perm_b32 v40, v4, v4, v32
  v_perm_b32 v41, v4, v4, v33
  v_perm_b32 v42, v4, v4, v34
  v_perm_b32 v43, v4, v4, v35
  s_nop 1
  v_mfma_f32_16x16x32_bf16 v[44:47], v[40:43], v[136:139], v[44:47]
  v_mfma_f32_16x16x32_bf16 v[48:51], v[40:43], v[140:143], v[48:51]
  v_mfma_f32_16x16x32_bf16 v[52:55], v[40:43], v[144:147], v[52:55]
  v_mfma_f32_16x16x32_bf16 v[56:59], v[40:43], v[148:151], v[56:59]
  v_mfma_f32_16x16x32_bf16 v[60:63], v[40:43], v[152:155], v[60:63]
  s_waitcnt vmcnt(1)
  buffer_load_dwordx4 v[104:107], v90, s[12:15], s43 offen offset:512
  s_waitcnt vmcnt(1)
  buffer_load_dwordx4 v[108:111], v90, s[12:15], s43 offen offset:768
  s_waitcnt vmcnt(1)
  buffer_load_dwordx4 v[112:115], v91, s[12:15], s43 offen
  s_waitcnt vmcnt(1)
  s_movk_i32 s43, 8064
  buffer_load_dwordx4 v[116:119], v90, s[12:15], s43 offen offset:0
  s_waitcnt vmcnt(1)
  buffer_load_dwordx4 v[120:123], v90, s[12:15], s43 offen offset:256
  v_perm_b32 v36, v5, v5, v28
  v_perm_b32 v37, v5, v5, v29
  v_perm_b32 v38, v5, v5, v30
  v_perm_b32 v39, v5, v5, v31
  s_nop 1
  v_mfma_f32_16x16x32_bf16 v[44:47], v[36:39], v[96:99], v[44:47]
  v_mfma_f32_16x16x32_bf16 v[48:51], v[36:39], v[100:103], v[48:51]
  v_mfma_f32_16x16x32_bf16 v[52:55], v[36:39], v[104:107], v[52:55]
  v_mfma_f32_16x16x32_bf16 v[56:59], v[36:39], v[108:111], v[56:59]
  v_mfma_f32_16x16x32_bf16 v[60:63], v[36:39], v[112:115], v[60:63]
  s_waitcnt vmcnt(1)
  buffer_load_dwordx4 v[124:127], v90, s[12:15], s43 offen offset:512
  s_waitcnt vmcnt(1)
  buffer_load_dwordx4 v[128:131], v90, s[12:15], s43 offen offset:768
  s_waitcnt vmcnt(1)
  buffer_load_dwordx4 v[132:135], v91, s[12:15], s43 offen
  s_waitcnt vmcnt(1)
  s_movk_i32 s43, 9216
  buffer_load_dwordx4 v[136:139], v90, s[12:15], s43 offen offset:0
  s_waitcnt vmcnt(1)
  buffer_load_dwordx4 v[140:143], v90, s[12:15], s43 offen offset:256
  v_perm_b32 v40, v5, v5, v32
  v_perm_b32 v41, v5, v5, v33
  v_perm_b32 v42, v5, v5, v34
  v_perm_b32 v43, v5, v5, v35
  s_nop 1
  v_mfma_f32_16x16x32_bf16 v[44:47], v[40:43], v[116:119], v[44:47]
  v_mfma_f32_16x16x32_bf16 v[48:51], v[40:43], v[120:123], v[48:51]
  v_mfma_f32_16x16x32_bf16 v[52:55], v[40:43], v[124:127], v[52:55]
  v_mfma_f32_16x16x32_bf16 v[56:59], v[40:43], v[128:131], v[56:59]
  v_mfma_f32_16x16x32_bf16 v[60:63], v[40:43], v[132:135], v[60:63]
  s_waitcnt vmcnt(1)
  buffer_load_dwordx4 v[144:147], v90, s[12:15], s43 offen offset:512
  s_waitcnt vmcnt(1)
  buffer_load_dwordx4 v[148:151], v90, s[12:15], s43 offen offset:768
  s_waitcnt vmcnt(1)
  buffer_load_dwordx4 v[152:155], v91, s[12:15], s43 offen
  s_waitcnt vmcnt(0)
  v_perm_b32 v36, v6, v6, v28
  v_perm_b32 v37, v6, v6, v29
  v_perm_b32 v38, v6, v6, v30
  v_perm_b32 v39, v6, v6, v31
  s_nop 1
  v_mfma_f32_16x16x32_bf16 v[44:47], v[36:39], v[136:139], v[44:47]
  v_mfma_f32_16x16x32_bf16 v[48:51], v[36:39], v[140:143], v[48:51]
  v_mfma_f32_16x16x32_bf16 v[52:55], v[36:39], v[144:147], v[52:55]
  v_mfma_f32_16x16x32_bf16 v[56:59], v[36:39], v[148:151], v[56:59]
  v_mfma_f32_16x16x32_bf16 v[60:63], v[36:39], v[152:155], v[60:63]
  s_mul_i32 s40, s39, 147456
  s_add_u32 s12, s22, s40
  s_addc_u32 s13, s23, 0
  s_mov_b32 s14, 147456
  s_mov_b32 s15, 0x20000
  v_lshrrev_b32 v18, 4, v0
  v_and_b32 v21, 15, v0
  v_lshlrev_b32 v19, 3, v18
  s_lshl_b32 s42, s62, 5
  v_add_u32 v19, s42, v19
  s_movk_i32 s43, 1152
  v_mul_lo_u32 v90, v19, s43
  v_lshl_add_u32 v90, v21, 4, v90
  v_add_u32 v91, 1024, v90
  v_mov_b32 v22, 0x7f000000
  v_cmp_gt_u32 vcc, 8, v21
  s_nop 1
  v_cndmask_b32 v91, v22, v91, vcc
  s_movk_i32 s43, 0
  buffer_load_dwordx4 v[96:99], v90, s[12:15], s43 offen offset:0
  buffer_load_dwordx4 v[100:103], v90, s[12:15], s43 offen offset:256
  buffer_load_dwordx4 v[104:107], v90, s[12:15], s43 offen offset:512
  s_waitcnt vmcnt(2)
  buffer_load_dwordx4 v[108:111], v90, s[12:15], s43 offen offset:768
  s_waitcnt vmcnt(2)
  buffer_load_dwordx4 v[112:115], v91, s[12:15], s43 offen
  s_waitcnt vmcnt(2)
  s_movk_i32 s43, 1152
  buffer_load_dwordx4 v[116:119], v90, s[12:15], s43 offen offset:0
  s_waitcnt vmcnt(2)
  buffer_load_dwordx4 v[120:123], v90, s[12:15], s43 offen offset:256
  s_waitcnt vmcnt(2)
  buffer_load_dwordx4 v[124:127], v90, s[12:15], s43 offen offset:512
  s_waitcnt vmcnt(2)
  buffer_load_dwordx4 v[128:131], v90, s[12:15], s43 offen offset:768
  s_waitcnt vmcnt(2)
  buffer_load_dwordx4 v[132:135], v91, s[12:15], s43 offen
  s_waitcnt vmcnt(2)
  s_movk_i32 s43, 2304
  buffer_load_dwordx4 v[136:139], v90, s[12:15], s43 offen offset:0
  s_waitcnt vmcnt(2)
  buffer_load_dwordx4 v[140:143], v90, s[12:15], s43 offen offset:256
  s_waitcnt vmcnt(2)
  buffer_load_dwordx4 v[144:147], v90, s[12:15], s43 offen offset:512
  s_waitcnt vmcnt(2)
  buffer_load_dwordx4 v[148:151], v90, s[12:15], s43 offen offset:768
  s_waitcnt vmcnt(2)
  buffer_load_dwordx4 v[152:155], v91, s[12:15], s43 offen
  s_waitcnt vmcnt(2)
  s_movk_i32 s43, 3456
  buffer_load_dwordx4 v[156:159], v90, s[12:15], s43 offen offset:0
  s_waitcnt vmcnt(2)
  buffer_load_dwordx4 v[160:163], v90, s[12:15], s43 offen offset:256
  s_waitcnt vmcnt(2)
  buffer_load_dwordx4 v[164:167], v90, s[12:15], s43 offen offset:512
  s_waitcnt vmcnt(2)
  buffer_load_dwordx4 v[168:171], v90, s[12:15], s43 offen offset:768
  s_waitcnt vmcnt(2)
  buffer_load_dwordx4 v[172:175], v91, s[12:15], s43 offen
  s_waitcnt vmcnt(2)
  s_movk_i32 s43, 4608
  buffer_load_dwordx4 v[176:179], v90, s[12:15], s43 offen offset:0
  s_waitcnt vmcnt(2)
  buffer_load_dwordx4 v[180:183], v90, s[12:15], s43 offen offset:256
  s_waitcnt vmcnt(2)
  buffer_load_dwordx4 v[184:187], v90, s[12:15], s43 offen offset:512
  s_waitcnt vmcnt(2)
  buffer_load_dwordx4 v[188:191], v90, s[12:15], s43 offen offset:768
  s_waitcnt vmcnt(2)
  buffer_load_dwordx4 v[192:195], v91, s[12:15], s43 offen
  s_waitcnt vmcnt(2)
  s_movk_i32 s43, 5760
  buffer_load_dwordx4 v[196:199], v90, s[12:15], s43 offen offset:0
  s_waitcnt vmcnt(2)
  buffer_load_dwordx4 v[200:203], v90, s[12:15], s43 offen offset:256
  s_waitcnt vmcnt(2)
  buffer_load_dwordx4 v[204:207], v90, s[12:15], s43 offen offset:512
  s_waitcnt vmcnt(2)
  buffer_load_dwordx4 v[208:211], v90, s[12:15], s43 offen offset:768
  s_waitcnt vmcnt(2)
  buffer_load_dwordx4 v[212:215], v91, s[12:15], s43 offen
  s_waitcnt vmcnt(2)
  s_movk_i32 s43, 6912
  buffer_load_dwordx4 v[216:219], v90, s[12:15], s43 offen offset:0
  s_waitcnt vmcnt(2)
  buffer_load_dwordx4 v[220:223], v90, s[12:15], s43 offen offset:256
  s_waitcnt vmcnt(2)
  buffer_load_dwordx4 v[224:227], v90, s[12:15], s43 offen offset:512
  s_waitcnt vmcnt(2)
  buffer_load_dwordx4 v[228:231], v90, s[12:15], s43 offen offset:768
  s_waitcnt vmcnt(2)
  buffer_load_dwordx4 v[232:235], v91, s[12:15], s43 offen
  s_waitcnt vmcnt(2)
  s_movk_i32 s43, 8064
  buffer_load_dwordx4 v[236:239], v90, s[12:15], s43 offen offset:0
  s_waitcnt vmcnt(2)
  buffer_load_dwordx4 v[240:243], v90, s[12:15], s43 offen offset:256
  s_waitcnt vmcnt(2)
  buffer_load_dwordx4 v[244:247], v90, s[12:15], s43 offen offset:512
  s_waitcnt vmcnt(2)
  buffer_load_dwordx4 v[248:251], v90, s[12:15], s43 offen offset:768
  s_waitcnt vmcnt(2)
  buffer_load_dwordx4 v[252:255], v91, s[12:15], s43 offen
  s_waitcnt vmcnt(0)
  v_lshlrev_b32 v92, 2, v19
  v_add_u32 v92, 138240, v92
  s_mul_i32 s40, s62, 2560
  s_add_u32 s40, s40, 140352
  v_add_u32 v93, s40, v95
  v_mov_b32 v94, 140288
  s_mov_b32 s48, 0x3fb8aa3b
  s_waitcnt vmcnt(0)
  s_cmp_lg_u32 s39, s38
  s_cbranch_scc1 L_started
  s_cmp_lg_u32 s62, 0
  s_cbranch_scc1 L_started
  s_lshl_b32 s40, s38, 5
  v_mov_b32 v17, s40
  s_mov_b32 s41, 200000
L_startchk:
  s_sub_u32 s41, s41, 1
  s_cbranch_scc1 L_started
  global_load_dword v18, v17, s[34:35] offset:4 sc1
  s_waitcnt vmcnt(0)
  v_readfirstlane_b32 s40, v18
  s_nop 3
  s_cmp_ge_u32 s40, 32
  s_cbranch_scc1 L_started
  s_sleep 8
  s_branch L_startchk
L_started:
  s_barrier
  ds_read_b128 v[72:75], v94
  ds_read_b128 v[76:79], v94 offset:16
  ds_read_b128 v[2:5], v92 offset:0
  ds_read_b128 v[6:9], v92 offset:16
  ds_read_b128 v[10:13], v92 offset:512
  ds_read_b128 v[14:17], v92 offset:528
  ds_read_b128 v[18:21], v92 offset:1024
  ds_read_b128 v[22:25], v92 offset:1040
  ds_read_b128 v[80:83], v92 offset:1536
  ds_read_b128 v[84:87], v92 offset:1552
  s_waitcnt lgkmcnt(8)
  v_max3_f32 v26, v72, v73, v74
  v_max_f32 v26, v26, v75
  v_sub_f32 v72, v72, v26
  v_sub_f32 v73, v73, v26
  v_sub_f32 v74, v74, v26
  v_sub_f32 v75, v75, v26
  v_mul_f32 v72, s48, v72
  v_mul_f32 v73, s48, v73
  v_mul_f32 v74, s48, v74
  v_mul_f32 v75, s48, v75
  v_exp_f32 v72, v72
  v_exp_f32 v73, v73
  v_exp_f32 v74, v74
  v_exp_f32 v75, v75
  s_nop 0
  v_mul_f32 v27, v72, v76
  v_fmac_f32 v27, v73, v77
  v_fmac_f32 v27, v74, v78
  v_fmac_f32 v27, v75, v79
  v_rcp_f32 v27, v27
  s_nop 0
  v_mul_f32 v72, v72, v27
  v_mul_f32 v73, v73, v27
  v_mul_f32 v74, v74, v27
  v_mul_f32 v75, v75, v27
  s_waitcnt lgkmcnt(0)
  v_mul_f32 v2, v2, v72
  v_mul_f32 v3, v3, v72
  v_mul_f32 v4, v4, v72
  v_mul_f32 v5, v5, v72
  v_mul_f32 v6, v6, v72
  v_mul_f32 v7, v7, v72
  v_mul_f32 v8, v8, v72
  v_mul_f32 v9, v9, v72
  v_fmac_f32 v2, v10, v73
  v_fmac_f32 v3, v11, v73
  v_fmac_f32 v4, v12, v73
  v_fmac_f32 v5, v13, v73
  v_fmac_f32 v6, v14, v73
  v_fmac_f32 v7, v15, v73
  v_fmac_f32 v8, v16, v73
  v_fmac_f32 v9, v17, v73
  v_fmac_f32 v2, v18, v74
  v_fmac_f32 v3, v19, v74
  v_fmac_f32 v4, v20, v74
  v_fmac_f32 v5, v21, v74
  v_fmac_f32 v6, v22, v74
  v_fmac_f32 v7, v23, v74
  v_fmac_f32 v8, v24, v74
  v_fmac_f32 v9, v25, v74
  v_fmac_f32 v2, v80, v75
  v_fmac_f32 v3, v81, v75
  v_fmac_f32 v4, v82, v75
  v_fmac_f32 v5, v83, v75
  v_fmac_f32 v6, v84, v75
  v_fmac_f32 v7, v85, v75
  v_fmac_f32 v8, v86, v75
  v_fmac_f32 v9, v87, v75
  v_cvt_pk_bf16_f32 v10, v2, v3
  v_cvt_pk_bf16_f32 v11, v4, v5
  v_cvt_pk_bf16_f32 v12, v6, v7
  v_cvt_pk_bf16_f32 v13, v8, v9
  v_perm_b32 v36, v10, v10, v28
  v_perm_b32 v37, v10, v10, v29
  v_perm_b32 v38, v10, v10, v30
  v_perm_b32 v39, v10, v10, v31
  v_perm_b32 v40, v10, v10, v32
  v_perm_b32 v41, v10, v10, v33
  v_perm_b32 v42, v10, v10, v34
  v_perm_b32 v43, v10, v10, v35
  v_mfma_f32_16x16x32_bf16 v[44:47], v[36:39], v[96:99], v[44:47]
  v_mfma_f32_16x16x32_bf16 v[48:51], v[36:39], v[100:103], v[48:51]
  v_mfma_f32_16x16x32_bf16 v[52:55], v[36:39], v[104:107], v[52:55]
  v_mfma_f32_16x16x32_bf16 v[56:59], v[36:39], v[108:111], v[56:59]
  v_mfma_f32_16x16x32_bf16 v[60:63], v[36:39], v[112:115], v[60:63]
  v_perm_b32 v36, v11, v11, v28
  v_perm_b32 v37, v11, v11, v29
  v_perm_b32 v38, v11, v11, v30
  v_perm_b32 v39, v11, v11, v31
  v_mfma_f32_16x16x32_bf16 v[44:47], v[40:43], v[116:119], v[44:47]
  v_mfma_f32_16x16x32_bf16 v[48:51], v[40:43], v[120:123], v[48:51]
  v_mfma_f32_16x16x32_bf16 v[52:55], v[40:43], v[124:127], v[52:55]
  v_mfma_f32_16x16x32_bf16 v[56:59], v[40:43], v[128:131], v[56:59]
  v_mfma_f32_16x16x32_bf16 v[60:63], v[40:43], v[132:135], v[60:63]
  v_perm_b32 v40, v11, v11, v32
  v_perm_b32 v41, v11, v11, v33
  v_perm_b32 v42, v11, v11, v34
  v_perm_b32 v43, v11, v11, v35
  v_mfma_f32_16x16x32_bf16 v[44:47], v[36:39], v[136:139], v[44:47]
  v_mfma_f32_16x16x32_bf16 v[48:51], v[36:39], v[140:143], v[48:51]
  v_mfma_f32_16x16x32_bf16 v[52:55], v[36:39], v[144:147], v[52:55]
  v_mfma_f32_16x16x32_bf16 v[56:59], v[36:39], v[148:151], v[56:59]
  v_mfma_f32_16x16x32_bf16 v[60:63], v[36:39], v[152:155], v[60:63]
  v_perm_b32 v36, v12, v12, v28
  v_perm_b32 v37, v12, v12, v29
  v_perm_b32 v38, v12, v12, v30
  v_perm_b32 v39, v12, v12, v31
  v_mfma_f32_16x16x32_bf16 v[44:47], v[40:43], v[156:159], v[44:47]
  v_mfma_f32_16x16x32_bf16 v[48:51], v[40:43], v[160:163], v[48:51]
  v_mfma_f32_16x16x32_bf16 v[52:55], v[40:43], v[164:167], v[52:55]
  v_mfma_f32_16x16x32_bf16 v[56:59], v[40:43], v[168:171], v[56:59]
  v_mfma_f32_16x16x32_bf16 v[60:63], v[40:43], v[172:175], v[60:63]
  v_perm_b32 v40, v12, v12, v32
  v_perm_b32 v41, v12, v12, v33
  v_perm_b32 v42, v12, v12, v34
  v_perm_b32 v43, v12, v12, v35
  v_mfma_f32_16x16x32_bf16 v[44:47], v[36:39], v[176:179], v[44:47]
  v_mfma_f32_16x16x32_bf16 v[48:51], v[36:39], v[180:183], v[48:51]
  v_mfma_f32_16x16x32_bf16 v[52:55], v[36:39], v[184:187], v[52:55]
  v_mfma_f32_16x16x32_bf16 v[56:59], v[36:39], v[188:191], v[56:59]
  v_mfma_f32_16x16x32_bf16 v[60:63], v[36:39], v[192:195], v[60:63]
  v_perm_b32 v36, v13, v13, v28
  v_perm_b32 v37, v13, v13, v29
  v_perm_b32 v38, v13, v13, v30
  v_perm_b32 v39, v13, v13, v31
  v_mfma_f32_16x16x32_bf16 v[44:47], v[40:43], v[196:199], v[44:47]
  v_mfma_f32_16x16x32_bf16 v[48:51], v[40:43], v[200:203], v[48:51]
  v_mfma_f32_16x16x32_bf16 v[52:55], v[40:43], v[204:207], v[52:55]
  v_mfma_f32_16x16x32_bf16 v[56:59], v[40:43], v[208:211], v[56:59]
  v_mfma_f32_16x16x32_bf16 v[60:63], v[40:43], v[212:215], v[60:63]
  v_perm_b32 v40, v13, v13, v32
  v_perm_b32 v41, v13, v13, v33
  v_perm_b32 v42, v13, v13, v34
  v_perm_b32 v43, v13, v13, v35
  v_mfma_f32_16x16x32_bf16 v[44:47], v[36:39], v[216:219], v[44:47]
  v_mfma_f32_16x16x32_bf16 v[48:51], v[36:39], v[220:223], v[48:51]
  v_mfma_f32_16x16x32_bf16 v[52:55], v[36:39], v[224:227], v[52:55]
  v_mfma_f32_16x16x32_bf16 v[56:59], v[36:39], v[228:231], v[56:59]
  v_mfma_f32_16x16x32_bf16 v[60:63], v[36:39], v[232:235], v[60:63]
  v_mfma_f32_16x16x32_bf16 v[44:47], v[40:43], v[236:239], v[44:47]
  v_mfma_f32_16x16x32_bf16 v[48:51], v[40:43], v[240:243], v[48:51]
  v_mfma_f32_16x16x32_bf16 v[52:55], v[40:43], v[244:247], v[52:55]
  v_mfma_f32_16x16x32_bf16 v[56:59], v[40:43], v[248:251], v[56:59]
  v_mfma_f32_16x16x32_bf16 v[60:63], v[40:43], v[252:255], v[60:63]
  s_mov_b32 exec_hi, 0
  s_nop 2
  ds_write_b128 v93, v[44:47] offset:0
  ds_write_b128 v93, v[48:51] offset:512
  ds_write_b128 v93, v[52:55] offset:1024
  ds_write_b128 v93, v[56:59] offset:1536
  ds_write_b128 v93, v[60:63] offset:2048
  s_mov_b64 exec, -1
  s_waitcnt lgkmcnt(0)
  s_barrier
  s_branch L_done
L_tail:
  s_lshl_b32 s40, s3, 10
  v_lshl_add_u32 v2, v0, 4, s40
  v_add_u32 v3, 140352, v2
  s_mul_i32 s40, s2, 2304
  s_add_u32 s56, s36, s40
  s_addc_u32 s57, s37, 0
  s_mov_b32 s58, 2304
  s_mov_b32 s59, 0x20000
  s_barrier
  s_cmp_ge_u32 s3, 3
  s_cbranch_scc1 L_done
  ds_read_b128 v[8:11], v3 offset:0
  ds_read_b128 v[12:15], v3 offset:2560
  ds_read_b128 v[16:19], v3 offset:5120
  ds_read_b128 v[20:23], v3 offset:7680
  s_waitcnt lgkmcnt(2)
  v_pk_add_f32 v[8:9], v[8:9], v[12:13]
  v_pk_add_f32 v[10:11], v[10:11], v[14:15]
  s_waitcnt lgkmcnt(0)
  v_pk_add_f32 v[16:17], v[16:17], v[20:21]
  v_pk_add_f32 v[18:19], v[18:19], v[22:23]
  v_pk_add_f32 v[8:9], v[8:9], v[16:17]
  v_pk_add_f32 v[10:11], v[10:11], v[18:19]
  buffer_store_dwordx4 v[8:11], v2, s[56:59], 0 offen sc1
  s_branch L_done
L_reducer:
  s_mov_b32 s40, 0
  buffer_load_dwordx4 v[112:115], v205, s[52:55], s40 offen sc1
  s_mov_b32 s40, 2304
  buffer_load_dwordx4 v[116:119], v204, s[52:55], s40 offen sc1
  s_mov_b32 s40, 4608
  buffer_load_dwordx4 v[120:123], v204, s[52:55], s40 offen sc1
  s_mov_b32 s40, 6912
  buffer_load_dwordx4 v[124:127], v204, s[52:55], s40 offen sc1
  s_mov_b32 s40, 9216
  buffer_load_dwordx4 v[128:131], v204, s[52:55], s40 offen sc1
  s_mov_b32 s40, 11520
  buffer_load_dwordx4 v[132:135], v204, s[52:55], s40 offen sc1
  s_mov_b32 s40, 13824
  buffer_load_dwordx4 v[136:139], v204, s[52:55], s40 offen sc1
  s_mov_b32 s40, 16128
  buffer_load_dwordx4 v[140:143], v204, s[52:55], s40 offen sc1
  s_mov_b32 s40, 18432
  buffer_load_dwordx4 v[144:147], v204, s[52:55], s40 offen sc1
  s_mov_b32 s40, 20736
  buffer_load_dwordx4 v[148:151], v204, s[52:55], s40 offen sc1
  s_mov_b32 s40, 23040
  buffer_load_dwordx4 v[152:155], v204, s[52:55], s40 offen sc1
  s_mov_b32 s40, 25344
  buffer_load_dwordx4 v[156:159], v204, s[52:55], s40 offen sc1
  s_mov_b32 s40, 27648
  buffer_load_dwordx4 v[160:163], v204, s[52:55], s40 offen sc1
  s_mov_b32 s40, 29952
  buffer_load_dwordx4 v[164:167], v204, s[52:55], s40 offen sc1
  s_mov_b32 s40, 32256
  buffer_load_dwordx4 v[168:171], v204, s[52:55], s40 offen sc1
  s_mov_b32 s40, 34560
  buffer_load_dwordx4 v[172:175], v204, s[52:55], s40 offen sc1
  buffer_load_dwordx4 v[176:179], v206, s[52:55], 0 offen sc1
  buffer_load_dwordx4 v[180:183], v207, s[52:55], 0 offen sc1
  s_barrier
  ds_read_b128 v[184:187], v208 offset:0
  ds_read_b128 v[188:191], v208 offset:2560
  ds_read_b128 v[192:195], v208 offset:5120
  ds_read_b128 v[196:199], v208 offset:7680
  s_waitcnt lgkmcnt(0)
  v_add_f32 v184, v184, v188
  v_add_f32 v192, v192, v196
  v_add_f32 v185, v185, v189
  v_add_f32 v193, v193, v197
  v_add_f32 v186, v186, v190
  v_add_f32 v194, v194, v198
  v_add_f32 v187, v187, v191
  v_add_f32 v195, v195, v199
  v_add_f32 v184, v184, v192
  v_add_f32 v185, v185, v193
  v_add_f32 v186, v186, v194
  v_add_f32 v187, v187, v195
  s_mov_b32 s41, 0xffff0000
  v_lshlrev_b32 v210, 16, v200
  v_and_b32 v211, s41, v200
  v_lshlrev_b32 v212, 16, v201
  v_and_b32 v213, s41, v201
  v_add_f32 v184, v184, v210
  v_add_f32 v185, v185, v211
  v_add_f32 v186, v186, v212
  v_add_f32 v187, v187, v213
  v_lshlrev_b32 v210, 16, v202
  v_and_b32 v211, s41, v202
  v_lshlrev_b32 v212, 16, v203
  v_and_b32 v213, s41, v203
  v_add_f32 v184, v184, v210
  v_add_f32 v185, v185, v211
  v_add_f32 v186, v186, v212
  v_add_f32 v187, v187, v213
  s_mul_i32 s40, s38, 1152
  s_add_u32 s56, s32, s40
  s_addc_u32 s57, s33, 0
  s_mov_b32 s58, 1152
  s_mov_b32 s59, 0x20000
  s_mov_b32 s47, 200000
L_poll:
  s_sub_u32 s47, s47, 1
  s_cbranch_scc1 L_pollok
  s_waitcnt vmcnt(0)
  v_pk_add_f32 v[214:215], v[112:113], v[144:145]
  v_pk_add_f32 v[216:217], v[114:115], v[146:147]
  v_pk_add_f32 v[218:219], v[116:117], v[148:149]
  v_pk_add_f32 v[220:221], v[118:119], v[150:151]
  v_pk_add_f32 v[222:223], v[120:121], v[152:153]
  v_pk_add_f32 v[224:225], v[122:123], v[154:155]
  v_pk_add_f32 v[226:227], v[124:125], v[156:157]
  v_pk_add_f32 v[228:229], v[126:127], v[158:159]
  v_pk_add_f32 v[230:231], v[128:129], v[160:161]
  v_pk_add_f32 v[232:233], v[130:131], v[162:163]
  v_pk_add_f32 v[234:235], v[132:133], v[164:165]
  v_pk_add_f32 v[236:237], v[134:135], v[166:167]
  v_pk_add_f32 v[238:239], v[136:137], v[168:169]
  v_pk_add_f32 v[240:241], v[138:139], v[170:171]
  v_pk_add_f32 v[242:243], v[140:141], v[172:173]
  v_pk_add_f32 v[244:245], v[142:143], v[174:175]
  v_pk_add_f32 v[246:247], v[176:177], v[180:181]
  v_pk_add_f32 v[248:249], v[178:179], v[182:183]
  v_pk_add_f32 v[214:215], v[214:215], v[230:231]
  v_pk_add_f32 v[216:217], v[216:217], v[232:233]
  v_pk_add_f32 v[218:219], v[218:219], v[234:235]
  v_pk_add_f32 v[220:221], v[220:221], v[236:237]
  v_pk_add_f32 v[222:223], v[222:223], v[238:239]
  v_pk_add_f32 v[224:225], v[224:225], v[240:241]
  v_pk_add_f32 v[226:227], v[226:227], v[242:243]
  v_pk_add_f32 v[228:229], v[228:229], v[244:245]
  v_pk_add_f32 v[214:215], v[214:215], v[222:223]
  v_pk_add_f32 v[216:217], v[216:217], v[224:225]
  v_pk_add_f32 v[218:219], v[218:219], v[226:227]
  v_pk_add_f32 v[220:221], v[220:221], v[228:229]
  v_pk_add_f32 v[214:215], v[214:215], v[218:219]
  v_pk_add_f32 v[216:217], v[216:217], v[220:221]
  v_pk_add_f32 v[218:219], v[214:215], v[216:217]
  v_pk_add_f32 v[220:221], v[246:247], v[248:249]
  v_pk_add_f32 v[218:219], v[218:219], v[220:221]
  v_cmp_u_f32 vcc, v218, v219
  s_cbranch_vccz L_pollok
  v_max3_u32 v210, v112, v113, v114
  v_max_u32 v210, v210, v115
  v_cmp_eq_u32 s[16:17], -1, v210
  v_max3_u32 v211, v116, v117, v118
  v_max_u32 v211, v211, v119
  v_cmp_eq_u32 s[18:19], -1, v211
  v_max3_u32 v212, v120, v121, v122
  v_max_u32 v212, v212, v123
  v_cmp_eq_u32 s[20:21], -1, v212
  v_max3_u32 v213, v124, v125, v126
  v_max_u32 v213, v213, v127
  v_cmp_eq_u32 s[22:23], -1, v213
  v_max3_u32 v210, v128, v129, v130
  v_max_u32 v210, v210, v131
  v_cmp_eq_u32 s[24:25], -1, v210
  v_max3_u32 v211, v132, v133, v134
  v_max_u32 v211, v211, v135
  v_cmp_eq_u32 s[26:27], -1, v211
  v_max3_u32 v212, v136, v137, v138
  v_max_u32 v212, v212, v139
  v_cmp_eq_u32 s[28:29], -1, v212
  v_max3_u32 v213, v140, v141, v142
  v_max_u32 v213, v213, v143
  v_cmp_eq_u32 s[30:31], -1, v213
  v_max3_u32 v210, v144, v145, v146
  v_max_u32 v210, v210, v147
  v_cmp_eq_u32 s[84:85], -1, v210
  v_max3_u32 v211, v148, v149, v150
  v_max_u32 v211, v211, v151
  v_cmp_eq_u32 s[86:87], -1, v211
  v_max3_u32 v212, v152, v153, v154
  v_max_u32 v212, v212, v155
  v_cmp_eq_u32 s[88:89], -1, v212
  v_max3_u32 v213, v156, v157, v158
  v_max_u32 v213, v213, v159
  v_cmp_eq_u32 s[90:91], -1, v213
  v_max3_u32 v210, v160, v161, v162
  v_max_u32 v210, v210, v163
  v_cmp_eq_u32 s[92:93], -1, v210
  v_max3_u32 v211, v164, v165, v166
  v_max_u32 v211, v211, v167
  v_cmp_eq_u32 s[94:95], -1, v211
  v_max3_u32 v212, v168, v169, v170
  v_max_u32 v212, v212, v171
  v_cmp_eq_u32 s[96:97], -1, v212
  v_max3_u32 v213, v172, v173, v174
  v_max_u32 v213, v213, v175
  v_cmp_eq_u32 s[98:99], -1, v213
  v_max3_u32 v210, v176, v177, v178
  v_max_u32 v210, v210, v179
  v_cmp_eq_u32 s[100:101], -1, v210
  v_max3_u32 v211, v180, v181, v182
  v_max_u32 v211, v211, v183
  v_cmp_eq_u32 s[4:5], -1, v211
  s_mov_b32 s42, 0
  s_nop 2
  s_cmp_lg_u64 s[16:17], 0
  s_cbranch_scc1 L_rl0
L_rb0:
  s_cmp_lg_u64 s[18:19], 0
  s_cbranch_scc1 L_rl1
L_rb1:
  s_cmp_lg_u64 s[20:21], 0
  s_cbranch_scc1 L_rl2
L_rb2:
  s_cmp_lg_u64 s[22:23], 0
  s_cbranch_scc1 L_rl3
L_rb3:
  s_cmp_lg_u64 s[24:25], 0
  s_cbranch_scc1 L_rl4
L_rb4:
  s_cmp_lg_u64 s[26:27], 0
  s_cbranch_scc1 L_rl5
L_rb5:
  s_cmp_lg_u64 s[28:29], 0
  s_cbranch_scc1 L_rl6
L_rb6:
  s_cmp_lg_u64 s[30:31], 0
  s_cbranch_scc1 L_rl7
L_rb7:
  s_cmp_lg_u64 s[84:85], 0
  s_cbranch_scc1 L_rl8
L_rb8:
  s_cmp_lg_u64 s[86:87], 0
  s_cbranch_scc1 L_rl9
L_rb9:
  s_cmp_lg_u64 s[88:89], 0
  s_cbranch_scc1 L_rl10
L_rb10:
  s_cmp_lg_u64 s[90:91], 0
  s_cbranch_scc1 L_rl11
L_rb11:
  s_cmp_lg_u64 s[92:93], 0
  s_cbranch_scc1 L_rl12
L_rb12:
  s_cmp_lg_u64 s[94:95], 0
  s_cbranch_scc1 L_rl13
L_rb13:
  s_cmp_lg_u64 s[96:97], 0
  s_cbranch_scc1 L_rl14
L_rb14:
  s_cmp_lg_u64 s[98:99], 0
  s_cbranch_scc1 L_rl15
L_rb15:
  s_cmp_lg_u64 s[100:101], 0
  s_cbranch_scc1 L_rl16
L_rb16:
  s_cmp_lg_u64 s[4:5], 0
  s_cbranch_scc1 L_rl17
L_rb17:
  s_cmp_lg_u32 s42, 0
  s_cbranch_scc1 L_poll
  s_branch L_pollok
L_rl0:
  s_mov_b64 exec, s[16:17]
  s_mov_b32 s40, 0
  buffer_load_dwordx4 v[112:115], v205, s[52:55], s40 offen sc1
  s_mov_b64 exec, -1
  s_mov_b32 s42, 1
  s_branch L_rb0
L_rl1:
  s_mov_b64 exec, s[18:19]
  s_mov_b32 s40, 2304
  buffer_load_dwordx4 v[116:119], v204, s[52:55], s40 offen sc1
  s_mov_b64 exec, -1
  s_mov_b32 s42, 1
  s_branch L_rb1
L_rl2:
  s_mov_b64 exec, s[20:21]
  s_mov_b32 s40, 4608
  buffer_load_dwordx4 v[120:123], v204, s[52:55], s40 offen sc1
  s_mov_b64 exec, -1
  s_mov_b32 s42, 1
  s_branch L_rb2
L_rl3:
  s_mov_b64 exec, s[22:23]
  s_mov_b32 s40, 6912
  buffer_load_dwordx4 v[124:127], v204, s[52:55], s40 offen sc1
  s_mov_b64 exec, -1
  s_mov_b32 s42, 1
  s_branch L_rb3
L_rl4:
  s_mov_b64 exec, s[24:25]
  s_mov_b32 s40, 9216
  buffer_load_dwordx4 v[128:131], v204, s[52:55], s40 offen sc1
  s_mov_b64 exec, -1
  s_mov_b32 s42, 1
  s_branch L_rb4
L_rl5:
  s_mov_b64 exec, s[26:27]
  s_mov_b32 s40, 11520
  buffer_load_dwordx4 v[132:135], v204, s[52:55], s40 offen sc1
  s_mov_b64 exec, -1
  s_mov_b32 s42, 1
  s_branch L_rb5
L_rl6:
  s_mov_b64 exec, s[28:29]
  s_mov_b32 s40, 13824
  buffer_load_dwordx4 v[136:139], v204, s[52:55], s40 offen sc1
  s_mov_b64 exec, -1
  s_mov_b32 s42, 1
  s_branch L_rb6
L_rl7:
  s_mov_b64 exec, s[30:31]
  s_mov_b32 s40, 16128
  buffer_load_dwordx4 v[140:143], v204, s[52:55], s40 offen sc1
  s_mov_b64 exec, -1
  s_mov_b32 s42, 1
  s_branch L_rb7
L_rl8:
  s_mov_b64 exec, s[84:85]
  s_mov_b32 s40, 18432
  buffer_load_dwordx4 v[144:147], v204, s[52:55], s40 offen sc1
  s_mov_b64 exec, -1
  s_mov_b32 s42, 1
  s_branch L_rb8
L_rl9:
  s_mov_b64 exec, s[86:87]
  s_mov_b32 s40, 20736
  buffer_load_dwordx4 v[148:151], v204, s[52:55], s40 offen sc1
  s_mov_b64 exec, -1
  s_mov_b32 s42, 1
  s_branch L_rb9
L_rl10:
  s_mov_b64 exec, s[88:89]
  s_mov_b32 s40, 23040
  buffer_load_dwordx4 v[152:155], v204, s[52:55], s40 offen sc1
  s_mov_b64 exec, -1
  s_mov_b32 s42, 1
  s_branch L_rb10
L_rl11:
  s_mov_b64 exec, s[90:91]
  s_mov_b32 s40, 25344
  buffer_load_dwordx4 v[156:159], v204, s[52:55], s40 offen sc1
  s_mov_b64 exec, -1
  s_mov_b32 s42, 1
  s_branch L_rb11
L_rl12:
  s_mov_b64 exec, s[92:93]
  s_mov_b32 s40, 27648
  buffer_load_dwordx4 v[160:163], v204, s[52:55], s40 offen sc1
  s_mov_b64 exec, -1
  s_mov_b32 s42, 1
  s_branch L_rb12
L_rl13:
  s_mov_b64 exec, s[94:95]
  s_mov_b32 s40, 29952
  buffer_load_dwordx4 v[164:167], v204, s[52:55], s40 offen sc1
  s_mov_b64 exec, -1
  s_mov_b32 s42, 1
  s_branch L_rb13
L_rl14:
  s_mov_b64 exec, s[96:97]
  s_mov_b32 s40, 32256
  buffer_load_dwordx4 v[168:171], v204, s[52:55], s40 offen sc1
  s_mov_b64 exec, -1
  s_mov_b32 s42, 1
  s_branch L_rb14
L_rl15:
  s_mov_b64 exec, s[98:99]
  s_mov_b32 s40, 34560
  buffer_load_dwordx4 v[172:175], v204, s[52:55], s40 offen sc1
  s_mov_b64 exec, -1
  s_mov_b32 s42, 1
  s_branch L_rb15
L_rl16:
  s_mov_b64 exec, s[100:101]
  buffer_load_dwordx4 v[176:179], v206, s[52:55], 0 offen sc1
  s_mov_b64 exec, -1
  s_mov_b32 s42, 1
  s_branch L_rb16
L_rl17:
  s_mov_b64 exec, s[4:5]
  buffer_load_dwordx4 v[180:183], v207, s[52:55], 0 offen sc1
  s_mov_b64 exec, -1
  s_mov_b32 s42, 1
  s_branch L_rb17
L_pollok:
  v_mov_b32 v112, v214
  v_mov_b32 v176, v246
  v_mov_b32 v113, v215
  v_mov_b32 v177, v247
  v_mov_b32 v114, v216
  v_mov_b32 v178, v248
  v_mov_b32 v115, v217
  v_mov_b32 v179, v249
  v_mov_b32 v120, v112
  v_mov_b32 v121, v113
  v_mov_b32 v122, v114
  v_mov_b32 v123, v115
  s_nop 1
  v_permlane32_swap_b32 v112, v120
  v_permlane32_swap_b32 v113, v121
  v_permlane32_swap_b32 v114, v122
  v_permlane32_swap_b32 v115, v123
  v_add_f32_dpp v176, v176, v176 row_ror:4 row_mask:0xf bank_mask:0xf
  v_add_f32_dpp v177, v177, v177 row_ror:4 row_mask:0xf bank_mask:0xf
  v_add_f32_dpp v178, v178, v178 row_ror:4 row_mask:0xf bank_mask:0xf
  v_add_f32_dpp v179, v179, v179 row_ror:4 row_mask:0xf bank_mask:0xf
  v_add_f32_dpp v176, v176, v176 row_ror:8 row_mask:0xf bank_mask:0xf
  v_add_f32_dpp v177, v177, v177 row_ror:8 row_mask:0xf bank_mask:0xf
  v_add_f32_dpp v178, v178, v178 row_ror:8 row_mask:0xf bank_mask:0xf
  v_add_f32_dpp v179, v179, v179 row_ror:8 row_mask:0xf bank_mask:0xf
  v_add_f32 v112, v112, v120
  v_add_f32 v113, v113, v121
  v_add_f32 v114, v114, v122
  v_add_f32 v115, v115, v123
  v_mov_b32 v180, v176
  v_mov_b32 v181, v177
  v_mov_b32 v182, v178
  v_mov_b32 v183, v179
  s_nop 1
  v_permlane16_swap_b32 v176, v180
  v_permlane16_swap_b32 v177, v181
  v_permlane16_swap_b32 v178, v182
  v_permlane16_swap_b32 v179, v183
  s_nop 1
  v_add_f32 v176, v176, v180
  v_add_f32 v177, v177, v181
  v_add_f32 v178, v178, v182
  v_add_f32 v179, v179, v183
  v_mov_b32 v180, v176
  v_mov_b32 v181, v177
  v_mov_b32 v182, v178
  v_mov_b32 v183, v179
  s_nop 1
  v_permlane32_swap_b32 v176, v180
  v_permlane32_swap_b32 v177, v181
  v_permlane32_swap_b32 v178, v182
  v_permlane32_swap_b32 v179, v183
  s_nop 1
  v_add_f32 v176, v176, v180
  v_add_f32 v177, v177, v181
  v_add_f32 v178, v178, v182
  v_add_f32 v179, v179, v183
  v_cmp_gt_u32 vcc, 32, v0
  s_mov_b32 s41, 0xffff0000
  s_nop 0
  v_cndmask_b32 v112, v176, v112, vcc
  v_cndmask_b32 v113, v177, v113, vcc
  v_cndmask_b32 v114, v178, v114, vcc
  v_cndmask_b32 v115, v179, v115, vcc
  v_add_f32 v112, v112, v184
  v_add_f32 v113, v113, v185
  v_add_f32 v114, v114, v186
  v_add_f32 v115, v115, v187
  v_cvt_pk_bf16_f32 v112, v112, v113
  v_cvt_pk_bf16_f32 v113, v114, v115
  buffer_store_dwordx2 v[112:113], v209, s[56:59], 0 offen
L_done:
L_exit:
  s_endpgm
.section .rodata,"a"
.p2align 6
.amdhsa_kernel parallel_sum__mha_block_cached__mixer_channel_mlp__decode_kernel
  .amdhsa_next_free_vgpr 256
  .amdhsa_next_free_sgpr 102
  .amdhsa_accum_offset 256
  .amdhsa_group_segment_fixed_size 0
  .amdhsa_kernarg_size 104
  .amdhsa_user_sgpr_count 2
  .amdhsa_user_sgpr_kernarg_segment_ptr 1
  .amdhsa_system_sgpr_workgroup_id_x 1
  .amdhsa_float_denorm_mode_32 3
.end_amdhsa_kernel
```
